```python
import torch

def _softmax(x, axis=-1):
    return torch.softmax(x, dim=axis)
def _gelu(x):
    return torch.nn.functional.gelu(x, approximate="tanh")
def _silu(x):
    return torch.nn.functional.silu(x)
def _sigmoid(x):
    return torch.sigmoid(x)
def _layernorm(x, axis=-1, eps=1e-5):
    m = x.mean(dim=axis, keepdim=True)
    v = x.var(dim=axis, keepdim=True, unbiased=False)
    return (x - m) / torch.sqrt(v + eps)
def _scatter_add(tgt, idx, src, axis=0):
    return tgt.clone().index_add_(axis, idx, src)
def _segment_sum(src, seg, n):
    out = torch.zeros((n,) + src.shape[1:], dtype=src.dtype)
    return out.index_add_(0, seg, src)
def _pad(x, pw):
    flat = tuple(v for pair in reversed(pw) for v in pair)
    return torch.nn.functional.pad(x, flat)

kernel_name = 'standalone__gqa_block_cached__near_ridge'

def setup_inputs():

    _w = (lambda a: (lambda t: t.to(torch.bfloat16) if t.is_floating_point() else t)(torch.as_tensor(a)))
    B, Sq, D = 8, 112, 640
    Hq, Hkv, Sk, Dh = 32, 32, 512, 128
    assert Hq % Hkv == 0, (Hq, Hkv)
    return {
        "x": _w((lambda *s: torch.randn(*s, dtype=torch.bfloat16) * 0.8)(B, Sq, D)),
        "k_cache": _w((lambda *s: torch.randn(*s, dtype=torch.bfloat16) * 0.8)(B, Hkv, Sk, Dh)),
        "v_cache": _w((lambda *s: torch.randn(*s, dtype=torch.bfloat16) * 0.05)(B, Hkv, Sk, Dh)),
        "wq": _w((lambda *s: torch.randn(*s, dtype=torch.bfloat16) * 0.8)(D, Hq * Dh) * (D ** -0.5)),
        "wo": _w((lambda *s: torch.randn(*s, dtype=torch.bfloat16) * 0.05)(Hq * Dh, D) * ((Hq * Dh) ** -0.5)),
    }

def reference(x, k_cache, v_cache, wq, wo):
    B, Sq, D = x.shape
    Hq, Dh = 32, 128
    Hkv = k_cache.shape[1]
    rep = Hq // Hkv
    q = (lambda x, *d: x.permute(*d))((x @ wq).reshape(B, Sq, Hq, Dh), 0, 2, 1, 3)
    k = (lambda x, n, axis: torch.repeat_interleave(x, n, dim=axis))(k_cache, rep, axis=1)
    v = (lambda x, n, axis: torch.repeat_interleave(x, n, dim=axis))(v_cache, rep, axis=1)
    scores = torch.einsum("bhqd,bhkd->bhqk", q, k) * (Dh ** -0.5)
    p = _softmax(scores, axis=-1)
    o = torch.einsum("bhqk,bhkd->bhqd", p, v)
    return (lambda x, *d: x.permute(*d))(o, 0, 2, 1, 3).reshape(B, Sq, Hq * Dh) @ wo
```

```asm
; @launch kernel=k1_kernel grid=(256,1,1) block=(256,1,1) lds=163840
; @launch kernel=k2_kernel grid=(256,1,1) block=(256,1,1) lds=143360
.amdgcn_target "amdgcn-amd-amdhsa--gfx950"
.text
.globl k1_kernel
.p2align 8
.type k1_kernel,@function
k1_kernel:
    s_cmp_ge_u32 s2, 256
    s_cbranch_scc1 k1_done
    s_load_dwordx4 s[4:7], s[0:1], 0
    s_load_dwordx4 s[44:47], s[0:1], 16
    s_load_dwordx2 s[48:49], s[0:1], 32
    s_load_dwordx2 s[50:51], s[0:1], 56
    v_and_b32 v1, 63, v0
    v_lshrrev_b32 v43, 6, v0
    s_nop 0
    v_readfirstlane_b32 s32, v43
    s_lshr_b32 s34, s2, 5
    s_and_b32 s36, s2, 7
    s_lshl_b32 s36, s36, 2
    s_lshr_b32 s37, s2, 3
    s_and_b32 s37, s37, 3
    s_add_u32 s35, s36, s37
    s_lshl_b32 s33, s32, 12
    s_mov_b32 s41, 0x3e0293ee
    s_waitcnt lgkmcnt(0)
    s_mov_b32 s8, s4
    s_and_b32 s9, s5, 0xffff
    s_mov_b32 s10, 1146880
    s_mov_b32 s11, 0x20000
    s_lshl_b32 s36, s34, 5
    s_add_u32 s36, s36, s35
    s_lshl_b32 s37, s36, 17
    s_add_u32 s12, s6, s37
    s_addc_u32 s13, s7, 0
    s_and_b32 s13, s13, 0xffff
    s_mov_b32 s14, 131072
    s_mov_b32 s15, 0x20000
    s_add_u32 s16, s44, s37
    s_addc_u32 s17, s45, 0
    s_and_b32 s17, s17, 0xffff
    s_mov_b32 s18, 131072
    s_mov_b32 s19, 0x20000
    s_mov_b32 s20, s46
    s_and_b32 s21, s47, 0xffff
    s_mov_b32 s22, 5242880
    s_mov_b32 s23, 0x20000
    s_mov_b32 s24, s50
    s_and_b32 s25, s51, 0xffff
    s_mov_b32 s26, 16777216
    s_mov_b32 s27, 0x20000
    s_mov_b32 s28, s48
    s_and_b32 s29, s49, 0xffff
    s_mov_b32 s30, 5242880
    s_mov_b32 s31, 0x20000
    s_add_u32 s68, s50, 33554432
    s_addc_u32 s69, s51, 0
    s_and_b32 s69, s69, 0xffff
    s_mov_b32 s70, 65536
    s_mov_b32 s71, 0x20000
    s_mul_i32 s40, s34, 143360
    s_lshl_b32 s42, s35, 8
    s_and_b32 s36, s35, 3
    s_mul_i32 s36, s36, 3
    s_add_u32 s52, s36, s34
    s_cmp_ge_u32 s52, 10
    s_cselect_b32 s36, 10, 0
    s_sub_u32 s52, s52, s36
    v_and_b32 v43, 15, v1
    v_lshrrev_b32 v44, 4, v1
    v_add_u32 v45, 0, v44
    v_xor_b32 v45, v45, v43
    v_lshlrev_b32 v45, 4, v45
    v_lshl_add_u32 v45, v44, 8, v45
    v_add_u32 v2, 0, v45
    v_add_u32 v2, s33, v2
    v_add_u32 v45, 4, v44
    v_xor_b32 v45, v45, v43
    v_lshlrev_b32 v45, 4, v45
    v_lshl_add_u32 v45, v44, 8, v45
    v_add_u32 v3, 1024, v45
    v_add_u32 v3, s33, v3
    v_add_u32 v45, 8, v44
    v_xor_b32 v45, v45, v43
    v_lshlrev_b32 v45, 4, v45
    v_lshl_add_u32 v45, v44, 8, v45
    v_add_u32 v4, 2048, v45
    v_add_u32 v4, s33, v4
    v_add_u32 v45, 12, v44
    v_xor_b32 v45, v45, v43
    v_lshlrev_b32 v45, 4, v45
    v_lshl_add_u32 v45, v44, 8, v45
    v_add_u32 v5, 3072, v45
    v_add_u32 v5, s33, v5
    v_lshlrev_b32 v45, 2, v44
    v_xor_b32 v45, v45, v43
    v_lshlrev_b32 v45, 4, v45
    v_lshl_add_u32 v6, v44, 8, v45
    v_add_u32 v6, s33, v6
    s_lshl_b32 s36, s32, 17
    v_add_u32 v46, 0, v44
    v_lshl_add_u32 v7, v46, 13, v45
    v_add_u32 v7, s36, v7
    v_add_u32 v46, 4, v44
    v_lshl_add_u32 v8, v46, 13, v45
    v_add_u32 v8, s36, v8
    v_add_u32 v46, 8, v44
    v_lshl_add_u32 v9, v46, 13, v45
    v_add_u32 v9, s36, v9
    v_add_u32 v46, 12, v44
    v_lshl_add_u32 v10, v46, 13, v45
    v_add_u32 v10, s36, v10
    v_and_b32 v45, 7, v1
    v_lshrrev_b32 v46, 3, v1
    s_mul_i32 s36, s32, 40960
    s_mov_b32 s37, 1280
    v_add_u32 v31, 0, v44
    v_and_b32 v31, 7, v31
    v_xor_b32 v31, v31, v45
    v_lshlrev_b32 v31, 4, v31
    v_add_u32 v32, 0, v46
    v_mul_lo_u32 v32, v32, s37
    v_add_u32 v11, v31, v32
    v_add_u32 v11, s36, v11
    v_mov_b32 v33, 0x7fff0000
    v_cmp_gt_u32 vcc, 143360, v11
    s_nop 1
    v_cndmask_b32 v11, v33, v11, vcc
    v_add_u32 v31, 4, v44
    v_and_b32 v31, 7, v31
    v_xor_b32 v31, v31, v45
    v_lshlrev_b32 v31, 4, v31
    v_add_u32 v32, 8, v46
    v_mul_lo_u32 v32, v32, s37
    v_add_u32 v12, v31, v32
    v_add_u32 v12, s36, v12
    v_mov_b32 v33, 0x7fff0000
    v_cmp_gt_u32 vcc, 143360, v12
    s_nop 1
    v_cndmask_b32 v12, v33, v12, vcc
    v_add_u32 v31, 8, v44
    v_and_b32 v31, 7, v31
    v_xor_b32 v31, v31, v45
    v_lshlrev_b32 v31, 4, v31
    v_add_u32 v32, 16, v46
    v_mul_lo_u32 v32, v32, s37
    v_add_u32 v13, v31, v32
    v_add_u32 v13, s36, v13
    v_mov_b32 v33, 0x7fff0000
    v_cmp_gt_u32 vcc, 143360, v13
    s_nop 1
    v_cndmask_b32 v13, v33, v13, vcc
    v_add_u32 v31, 12, v44
    v_and_b32 v31, 7, v31
    v_xor_b32 v31, v31, v45
    v_lshlrev_b32 v31, 4, v31
    v_add_u32 v32, 24, v46
    v_mul_lo_u32 v32, v32, s37
    v_add_u32 v14, v31, v32
    v_add_u32 v14, s36, v14
    v_mov_b32 v33, 0x7fff0000
    v_cmp_gt_u32 vcc, 143360, v14
    s_nop 1
    v_cndmask_b32 v14, v33, v14, vcc
    v_and_b32 v45, 31, v1
    v_lshrrev_b32 v46, 5, v1
    v_lshrrev_b32 v31, 1, v45
    v_and_b32 v31, 7, v31
    v_lshlrev_b32 v32, 7, v45
    v_add_u32 v32, s33, v32
    v_add_u32 v33, 0, v46
    v_xor_b32 v33, v33, v31
    v_lshl_add_u32 v15, v33, 4, v32
    v_add_u32 v33, 2, v46
    v_xor_b32 v33, v33, v31
    v_lshl_add_u32 v16, v33, 4, v32
    v_add_u32 v33, 4, v46
    v_xor_b32 v33, v33, v31
    v_lshl_add_u32 v17, v33, 4, v32
    v_add_u32 v33, 6, v46
    v_xor_b32 v33, v33, v31
    v_lshl_add_u32 v18, v33, 4, v32
    v_and_b32 v31, 0x13, v45
    v_and_b32 v32, 4, v45
    v_and_b32 v33, 8, v45
    v_lshlrev_b32 v32, 1, v32
    v_lshrrev_b32 v33, 1, v33
    v_or3_b32 v31, v31, v32, v33
    v_and_b32 v32, 15, v31
    v_add_u32 v33, 0, v46
    v_xor_b32 v33, v33, v32
    v_lshlrev_b32 v33, 4, v33
    v_lshl_add_u32 v23, v31, 8, v33
    v_add_u32 v33, 2, v46
    v_xor_b32 v33, v33, v32
    v_lshlrev_b32 v33, 4, v33
    v_lshl_add_u32 v24, v31, 8, v33
    v_add_u32 v33, 4, v46
    v_xor_b32 v33, v33, v32
    v_lshlrev_b32 v33, 4, v33
    v_lshl_add_u32 v25, v31, 8, v33
    v_add_u32 v33, 6, v46
    v_xor_b32 v33, v33, v32
    v_lshlrev_b32 v33, 4, v33
    v_lshl_add_u32 v26, v31, 8, v33
    v_add_u32 v33, 8, v46
    v_xor_b32 v33, v33, v32
    v_lshlrev_b32 v33, 4, v33
    v_lshl_add_u32 v27, v31, 8, v33
    v_add_u32 v33, 10, v46
    v_xor_b32 v33, v33, v32
    v_lshlrev_b32 v33, 4, v33
    v_lshl_add_u32 v28, v31, 8, v33
    v_add_u32 v33, 12, v46
    v_xor_b32 v33, v33, v32
    v_lshlrev_b32 v33, 4, v33
    v_lshl_add_u32 v29, v31, 8, v33
    v_add_u32 v33, 14, v46
    v_xor_b32 v33, v33, v32
    v_lshlrev_b32 v33, 4, v33
    v_lshl_add_u32 v30, v31, 8, v33
    v_lshrrev_b32 v31, 2, v43
    v_and_b32 v32, 3, v43
    v_lshrrev_b32 v33, 1, v44
    v_lshl_add_u32 v33, v33, 3, v31
    v_and_b32 v35, 1, v32
    v_lshrrev_b32 v36, 1, v32
    v_lshl_or_b32 v34, v35, 1, v36
    v_and_b32 v35, 1, v44
    v_lshl_add_u32 v34, v35, 2, v34
    v_lshrrev_b32 v35, 1, v34
    v_and_b32 v36, 1, v34
    v_lshlrev_b32 v36, 3, v36
    v_lshl_add_u32 v36, v33, 8, v36
    v_lshlrev_b32 v37, 2, v31
    v_add_u32 v38, 0, v35
    v_xor_b32 v38, v38, v37
    v_lshl_add_u32 v19, v38, 4, v36
    v_add_u32 v38, 4, v35
    v_xor_b32 v38, v38, v37
    v_lshl_add_u32 v20, v38, 4, v36
    v_add_u32 v38, 8, v35
    v_xor_b32 v38, v38, v37
    v_lshl_add_u32 v21, v38, 4, v36
    v_add_u32 v38, 12, v35
    v_xor_b32 v38, v38, v37
    v_lshl_add_u32 v22, v38, 4, v36
    s_lshl_b32 s36, s32, 5
    v_add_u32 v31, s36, v45
    v_lshrrev_b32 v32, 4, v31
    s_mul_i32 s37, s34, 7
    v_add_u32 v32, s37, v32
    v_lshlrev_b32 v32, 17, v32
    v_and_b32 v33, 15, v31
    v_lshl_add_u32 v32, v33, 4, v32
    v_lshl_add_u32 v32, v46, 8, v32
    s_lshl_b32 s37, s35, 12
    v_add_u32 v32, s37, v32
    v_mov_b32 v33, 0x7fff0000
    v_cmp_gt_u32 vcc, 112, v31
    s_nop 1
    v_cndmask_b32 v47, v33, v32, vcc
    s_add_u32 m0, s33, 0
    s_lshl_b32 s37, s52, 19
    s_add_u32 s37, s37, s42
    s_mov_b32 s36, s37
    buffer_load_dwordx4 v7, s[20:23], s36 offen  lds
    s_add_u32 m0, s33, 1024
    s_mov_b32 s36, s37
    buffer_load_dwordx4 v8, s[20:23], s36 offen  lds
    s_add_u32 m0, s33, 2048
    s_mov_b32 s36, s37
    buffer_load_dwordx4 v9, s[20:23], s36 offen  lds
    s_add_u32 m0, s33, 3072
    s_mov_b32 s36, s37
    buffer_load_dwordx4 v10, s[20:23], s36 offen  lds
    s_add_u32 m0, s33, 16384
    s_lshl_b32 s37, s52, 7
    s_add_u32 s37, s37, s40
    s_mov_b32 s36, s37
    buffer_load_dwordx4 v11, s[8:11], s36 offen  lds
    s_add_u32 m0, s33, 17408
    s_mov_b32 s36, s37
    buffer_load_dwordx4 v12, s[8:11], s36 offen  lds
    s_add_u32 m0, s33, 18432
    s_mov_b32 s36, s37
    buffer_load_dwordx4 v13, s[8:11], s36 offen  lds
    s_add_u32 m0, s33, 19456
    s_mov_b32 s36, s37
    buffer_load_dwordx4 v14, s[8:11], s36 offen  lds
    s_add_u32 s52, s52, 1
    s_cmp_ge_u32 s52, 10
    s_cselect_b32 s52, 0, s52
    s_add_u32 m0, s33, 32768
    s_lshl_b32 s37, s52, 19
    s_add_u32 s37, s37, s42
    s_mov_b32 s36, s37
    buffer_load_dwordx4 v7, s[20:23], s36 offen  lds
    s_add_u32 m0, s33, 33792
    s_mov_b32 s36, s37
    buffer_load_dwordx4 v8, s[20:23], s36 offen  lds
    s_add_u32 m0, s33, 34816
    s_mov_b32 s36, s37
    buffer_load_dwordx4 v9, s[20:23], s36 offen  lds
    s_add_u32 m0, s33, 35840
    s_mov_b32 s36, s37
    buffer_load_dwordx4 v10, s[20:23], s36 offen  lds
    s_add_u32 m0, s33, 49152
    s_lshl_b32 s37, s52, 7
    s_add_u32 s37, s37, s40
    s_mov_b32 s36, s37
    buffer_load_dwordx4 v11, s[8:11], s36 offen  lds
    s_add_u32 m0, s33, 50176
    s_mov_b32 s36, s37
    buffer_load_dwordx4 v12, s[8:11], s36 offen  lds
    s_add_u32 m0, s33, 51200
    s_mov_b32 s36, s37
    buffer_load_dwordx4 v13, s[8:11], s36 offen  lds
    s_add_u32 m0, s33, 52224
    s_mov_b32 s36, s37
    buffer_load_dwordx4 v14, s[8:11], s36 offen  lds
    s_add_u32 s52, s52, 1
    s_cmp_ge_u32 s52, 10
    s_cselect_b32 s52, 0, s52
    s_add_u32 m0, s33, 65536
    s_mov_b32 s36, 0
    buffer_load_dwordx4 v2, s[12:15], s36 offen nt lds
    s_add_u32 m0, s33, 66560
    s_mov_b32 s36, 0
    buffer_load_dwordx4 v3, s[12:15], s36 offen nt lds
    s_add_u32 m0, s33, 67584
    s_mov_b32 s36, 0
    buffer_load_dwordx4 v4, s[12:15], s36 offen nt lds
    s_add_u32 m0, s33, 68608
    s_mov_b32 s36, 0
    buffer_load_dwordx4 v5, s[12:15], s36 offen nt lds
    s_add_u32 m0, s33, 81920
    s_lshl_b32 s37, s52, 19
    s_add_u32 s37, s37, s42
    s_mov_b32 s36, s37
    buffer_load_dwordx4 v7, s[20:23], s36 offen  lds
    s_add_u32 m0, s33, 82944
    s_mov_b32 s36, s37
    buffer_load_dwordx4 v8, s[20:23], s36 offen  lds
    s_add_u32 m0, s33, 83968
    s_mov_b32 s36, s37
    buffer_load_dwordx4 v9, s[20:23], s36 offen  lds
    s_add_u32 m0, s33, 84992
    s_mov_b32 s36, s37
    buffer_load_dwordx4 v10, s[20:23], s36 offen  lds
    s_add_u32 m0, s33, 98304
    s_lshl_b32 s37, s52, 7
    s_add_u32 s37, s37, s40
    s_mov_b32 s36, s37
    buffer_load_dwordx4 v11, s[8:11], s36 offen  lds
    s_add_u32 m0, s33, 99328
    s_mov_b32 s36, s37
    buffer_load_dwordx4 v12, s[8:11], s36 offen  lds
    s_add_u32 m0, s33, 100352
    s_mov_b32 s36, s37
    buffer_load_dwordx4 v13, s[8:11], s36 offen  lds
    s_add_u32 m0, s33, 101376
    s_mov_b32 s36, s37
    buffer_load_dwordx4 v14, s[8:11], s36 offen  lds
    s_add_u32 s52, s52, 1
    s_cmp_ge_u32 s52, 10
    s_cselect_b32 s52, 0, s52
    s_add_u32 m0, s33, 114688
    s_mov_b32 s36, 16384
    buffer_load_dwordx4 v2, s[12:15], s36 offen nt lds
    s_add_u32 m0, s33, 115712
    s_mov_b32 s36, 16384
    buffer_load_dwordx4 v3, s[12:15], s36 offen nt lds
    s_add_u32 m0, s33, 116736
    s_mov_b32 s36, 16384
    buffer_load_dwordx4 v4, s[12:15], s36 offen nt lds
    s_add_u32 m0, s33, 117760
    s_mov_b32 s36, 16384
    buffer_load_dwordx4 v5, s[12:15], s36 offen nt lds
    s_add_u32 m0, s33, 131072
    s_lshl_b32 s37, s52, 19
    s_add_u32 s37, s37, s42
    s_mov_b32 s36, s37
    buffer_load_dwordx4 v7, s[20:23], s36 offen  lds
    s_add_u32 m0, s33, 132096
    s_mov_b32 s36, s37
    buffer_load_dwordx4 v8, s[20:23], s36 offen  lds
    s_add_u32 m0, s33, 133120
    s_mov_b32 s36, s37
    buffer_load_dwordx4 v9, s[20:23], s36 offen  lds
    s_add_u32 m0, s33, 134144
    s_mov_b32 s36, s37
    buffer_load_dwordx4 v10, s[20:23], s36 offen  lds
    s_add_u32 m0, s33, 147456
    s_lshl_b32 s37, s52, 7
    s_add_u32 s37, s37, s40
    s_mov_b32 s36, s37
    buffer_load_dwordx4 v11, s[8:11], s36 offen  lds
    s_add_u32 m0, s33, 148480
    s_mov_b32 s36, s37
    buffer_load_dwordx4 v12, s[8:11], s36 offen  lds
    s_add_u32 m0, s33, 149504
    s_mov_b32 s36, s37
    buffer_load_dwordx4 v13, s[8:11], s36 offen  lds
    s_add_u32 m0, s33, 150528
    s_mov_b32 s36, s37
    buffer_load_dwordx4 v14, s[8:11], s36 offen  lds
    s_add_u32 s52, s52, 1
    s_cmp_ge_u32 s52, 10
    s_cselect_b32 s52, 0, s52
    s_waitcnt vmcnt(32) lgkmcnt(0)
    s_barrier
    v_add_u32 v31, 0, v19
    v_add_u32 v32, 0, v20
    v_add_u32 v33, 0, v21
    v_add_u32 v34, 0, v22
    v_add_u32 v35, 16384, v15
    v_add_u32 v36, 16384, v16
    v_add_u32 v37, 16384, v17
    v_add_u32 v38, 16384, v18
    ds_read_b128 a[48:51], v35
    ds_read_b64_tr_b16 a[32:33], v31 offset:0
    ds_read_b64_tr_b16 a[34:35], v31 offset:1024
    ds_read_b64_tr_b16 a[36:37], v32 offset:0
    ds_read_b64_tr_b16 a[38:39], v32 offset:1024
    ds_read_b64_tr_b16 a[40:41], v33 offset:0
    ds_read_b64_tr_b16 a[42:43], v33 offset:1024
    ds_read_b64_tr_b16 a[44:45], v34 offset:0
    ds_read_b64_tr_b16 a[46:47], v34 offset:1024
    ds_read_b128 a[68:71], v36
    ds_read_b64_tr_b16 a[52:53], v31 offset:4096
    ds_read_b64_tr_b16 a[54:55], v31 offset:5120
    ds_read_b64_tr_b16 a[56:57], v32 offset:4096
    ds_read_b64_tr_b16 a[58:59], v32 offset:5120
    ds_read_b64_tr_b16 a[60:61], v33 offset:4096
    ds_read_b64_tr_b16 a[62:63], v33 offset:5120
    ds_read_b64_tr_b16 a[64:65], v34 offset:4096
    ds_read_b64_tr_b16 a[66:67], v34 offset:5120
    s_waitcnt lgkmcnt(9)
    v_mfma_f32_32x32x16_bf16 v[48:63], a[32:35], a[48:51], 0
    v_mfma_f32_32x32x16_bf16 v[64:79], a[36:39], a[48:51], 0
    v_mfma_f32_32x32x16_bf16 v[80:95], a[40:43], a[48:51], 0
    v_mfma_f32_32x32x16_bf16 v[96:111], a[44:47], a[48:51], 0
    ds_read_b128 a[48:51], v37
    ds_read_b64_tr_b16 a[32:33], v31 offset:8192
    ds_read_b64_tr_b16 a[34:35], v31 offset:9216
    ds_read_b64_tr_b16 a[36:37], v32 offset:8192
    ds_read_b64_tr_b16 a[38:39], v32 offset:9216
    ds_read_b64_tr_b16 a[40:41], v33 offset:8192
    ds_read_b64_tr_b16 a[42:43], v33 offset:9216
    ds_read_b64_tr_b16 a[44:45], v34 offset:8192
    ds_read_b64_tr_b16 a[46:47], v34 offset:9216
    s_waitcnt lgkmcnt(9)
    v_mfma_f32_32x32x16_bf16 v[48:63], a[52:55], a[68:71], v[48:63]
    v_mfma_f32_32x32x16_bf16 v[64:79], a[56:59], a[68:71], v[64:79]
    v_mfma_f32_32x32x16_bf16 v[80:95], a[60:63], a[68:71], v[80:95]
    v_mfma_f32_32x32x16_bf16 v[96:111], a[64:67], a[68:71], v[96:111]
    ds_read_b128 a[68:71], v38
    ds_read_b64_tr_b16 a[52:53], v31 offset:12288
    ds_read_b64_tr_b16 a[54:55], v31 offset:13312
    ds_read_b64_tr_b16 a[56:57], v32 offset:12288
    ds_read_b64_tr_b16 a[58:59], v32 offset:13312
    ds_read_b64_tr_b16 a[60:61], v33 offset:12288
    ds_read_b64_tr_b16 a[62:63], v33 offset:13312
    ds_read_b64_tr_b16 a[64:65], v34 offset:12288
    ds_read_b64_tr_b16 a[66:67], v34 offset:13312
    s_waitcnt lgkmcnt(9)
    v_mfma_f32_32x32x16_bf16 v[48:63], a[32:35], a[48:51], v[48:63]
    v_mfma_f32_32x32x16_bf16 v[64:79], a[36:39], a[48:51], v[64:79]
    v_mfma_f32_32x32x16_bf16 v[80:95], a[40:43], a[48:51], v[80:95]
    v_mfma_f32_32x32x16_bf16 v[96:111], a[44:47], a[48:51], v[96:111]
    s_waitcnt lgkmcnt(0)
    v_mfma_f32_32x32x16_bf16 v[48:63], a[52:55], a[68:71], v[48:63]
    v_mfma_f32_32x32x16_bf16 v[64:79], a[56:59], a[68:71], v[64:79]
    v_mfma_f32_32x32x16_bf16 v[80:95], a[60:63], a[68:71], v[80:95]
    v_mfma_f32_32x32x16_bf16 v[96:111], a[64:67], a[68:71], v[96:111]
    s_waitcnt vmcnt(24) lgkmcnt(0)
    s_barrier
    s_add_u32 m0, s33, 0
    s_mov_b32 s36, 32768
    buffer_load_dwordx4 v2, s[12:15], s36 offen nt lds
    s_add_u32 m0, s33, 1024
    s_mov_b32 s36, 32768
    buffer_load_dwordx4 v3, s[12:15], s36 offen nt lds
    s_add_u32 m0, s33, 2048
    s_mov_b32 s36, 32768
    buffer_load_dwordx4 v4, s[12:15], s36 offen nt lds
    s_add_u32 m0, s33, 3072
    s_mov_b32 s36, 32768
    buffer_load_dwordx4 v5, s[12:15], s36 offen nt lds
    s_add_u32 m0, s33, 16384
    s_lshl_b32 s37, s52, 19
    s_add_u32 s37, s37, s42
    s_mov_b32 s36, s37
    buffer_load_dwordx4 v7, s[20:23], s36 offen  lds
    s_add_u32 m0, s33, 17408
    s_mov_b32 s36, s37
    buffer_load_dwordx4 v8, s[20:23], s36 offen  lds
    s_add_u32 m0, s33, 18432
    s_mov_b32 s36, s37
    buffer_load_dwordx4 v9, s[20:23], s36 offen  lds
    s_add_u32 m0, s33, 19456
    s_mov_b32 s36, s37
    buffer_load_dwordx4 v10, s[20:23], s36 offen  lds
    v_add_u32 v31, 32768, v19
    v_add_u32 v32, 32768, v20
    v_add_u32 v33, 32768, v21
    v_add_u32 v34, 32768, v22
    v_add_u32 v35, 49152, v15
    v_add_u32 v36, 49152, v16
    v_add_u32 v37, 49152, v17
    v_add_u32 v38, 49152, v18
    ds_read_b128 a[48:51], v35
    ds_read_b64_tr_b16 a[32:33], v31 offset:0
    ds_read_b64_tr_b16 a[34:35], v31 offset:1024
    ds_read_b64_tr_b16 a[36:37], v32 offset:0
    ds_read_b64_tr_b16 a[38:39], v32 offset:1024
    ds_read_b64_tr_b16 a[40:41], v33 offset:0
    ds_read_b64_tr_b16 a[42:43], v33 offset:1024
    ds_read_b64_tr_b16 a[44:45], v34 offset:0
    ds_read_b64_tr_b16 a[46:47], v34 offset:1024
    ds_read_b128 a[68:71], v36
    ds_read_b64_tr_b16 a[52:53], v31 offset:4096
    ds_read_b64_tr_b16 a[54:55], v31 offset:5120
    ds_read_b64_tr_b16 a[56:57], v32 offset:4096
    ds_read_b64_tr_b16 a[58:59], v32 offset:5120
    ds_read_b64_tr_b16 a[60:61], v33 offset:4096
    ds_read_b64_tr_b16 a[62:63], v33 offset:5120
    ds_read_b64_tr_b16 a[64:65], v34 offset:4096
    ds_read_b64_tr_b16 a[66:67], v34 offset:5120
    s_waitcnt lgkmcnt(9)
    v_mfma_f32_32x32x16_bf16 v[48:63], a[32:35], a[48:51], v[48:63]
    v_mfma_f32_32x32x16_bf16 v[64:79], a[36:39], a[48:51], v[64:79]
    v_mfma_f32_32x32x16_bf16 v[80:95], a[40:43], a[48:51], v[80:95]
    v_mfma_f32_32x32x16_bf16 v[96:111], a[44:47], a[48:51], v[96:111]
    ds_read_b128 a[48:51], v37
    ds_read_b64_tr_b16 a[32:33], v31 offset:8192
    ds_read_b64_tr_b16 a[34:35], v31 offset:9216
    ds_read_b64_tr_b16 a[36:37], v32 offset:8192
    ds_read_b64_tr_b16 a[38:39], v32 offset:9216
    ds_read_b64_tr_b16 a[40:41], v33 offset:8192
    ds_read_b64_tr_b16 a[42:43], v33 offset:9216
    ds_read_b64_tr_b16 a[44:45], v34 offset:8192
    ds_read_b64_tr_b16 a[46:47], v34 offset:9216
    s_waitcnt lgkmcnt(9)
    v_mfma_f32_32x32x16_bf16 v[48:63], a[52:55], a[68:71], v[48:63]
    v_mfma_f32_32x32x16_bf16 v[64:79], a[56:59], a[68:71], v[64:79]
    v_mfma_f32_32x32x16_bf16 v[80:95], a[60:63], a[68:71], v[80:95]
    v_mfma_f32_32x32x16_bf16 v[96:111], a[64:67], a[68:71], v[96:111]
    ds_read_b128 a[68:71], v38
    ds_read_b64_tr_b16 a[52:53], v31 offset:12288
    ds_read_b64_tr_b16 a[54:55], v31 offset:13312
    ds_read_b64_tr_b16 a[56:57], v32 offset:12288
    ds_read_b64_tr_b16 a[58:59], v32 offset:13312
    ds_read_b64_tr_b16 a[60:61], v33 offset:12288
    ds_read_b64_tr_b16 a[62:63], v33 offset:13312
    ds_read_b64_tr_b16 a[64:65], v34 offset:12288
    ds_read_b64_tr_b16 a[66:67], v34 offset:13312
    s_waitcnt lgkmcnt(9)
    v_mfma_f32_32x32x16_bf16 v[48:63], a[32:35], a[48:51], v[48:63]
    v_mfma_f32_32x32x16_bf16 v[64:79], a[36:39], a[48:51], v[64:79]
    v_mfma_f32_32x32x16_bf16 v[80:95], a[40:43], a[48:51], v[80:95]
    v_mfma_f32_32x32x16_bf16 v[96:111], a[44:47], a[48:51], v[96:111]
    s_waitcnt lgkmcnt(0)
    v_mfma_f32_32x32x16_bf16 v[48:63], a[52:55], a[68:71], v[48:63]
    v_mfma_f32_32x32x16_bf16 v[64:79], a[56:59], a[68:71], v[64:79]
    v_mfma_f32_32x32x16_bf16 v[80:95], a[60:63], a[68:71], v[80:95]
    v_mfma_f32_32x32x16_bf16 v[96:111], a[64:67], a[68:71], v[96:111]
    s_waitcnt vmcnt(20) lgkmcnt(0)
    s_barrier
    s_add_u32 m0, s33, 32768
    s_lshl_b32 s37, s52, 7
    s_add_u32 s37, s37, s40
    s_mov_b32 s36, s37
    buffer_load_dwordx4 v11, s[8:11], s36 offen  lds
    s_add_u32 m0, s33, 33792
    s_mov_b32 s36, s37
    buffer_load_dwordx4 v12, s[8:11], s36 offen  lds
    s_add_u32 m0, s33, 34816
    s_mov_b32 s36, s37
    buffer_load_dwordx4 v13, s[8:11], s36 offen  lds
    s_add_u32 m0, s33, 35840
    s_mov_b32 s36, s37
    buffer_load_dwordx4 v14, s[8:11], s36 offen  lds
    s_add_u32 s52, s52, 1
    s_cmp_ge_u32 s52, 10
    s_cselect_b32 s52, 0, s52
    s_add_u32 m0, s33, 49152
    s_mov_b32 s36, 49152
    buffer_load_dwordx4 v2, s[12:15], s36 offen nt lds
    s_add_u32 m0, s33, 50176
    s_mov_b32 s36, 49152
    buffer_load_dwordx4 v3, s[12:15], s36 offen nt lds
    s_add_u32 m0, s33, 51200
    s_mov_b32 s36, 49152
    buffer_load_dwordx4 v4, s[12:15], s36 offen nt lds
    s_add_u32 m0, s33, 52224
    s_mov_b32 s36, 49152
    buffer_load_dwordx4 v5, s[12:15], s36 offen nt lds
    v_add_u32 v31, 81920, v19
    v_add_u32 v32, 81920, v20
    v_add_u32 v33, 81920, v21
    v_add_u32 v34, 81920, v22
    v_add_u32 v35, 98304, v15
    v_add_u32 v36, 98304, v16
    v_add_u32 v37, 98304, v17
    v_add_u32 v38, 98304, v18
    ds_read_b128 a[48:51], v35
    ds_read_b64_tr_b16 a[32:33], v31 offset:0
    ds_read_b64_tr_b16 a[34:35], v31 offset:1024
    ds_read_b64_tr_b16 a[36:37], v32 offset:0
    ds_read_b64_tr_b16 a[38:39], v32 offset:1024
    ds_read_b64_tr_b16 a[40:41], v33 offset:0
    ds_read_b64_tr_b16 a[42:43], v33 offset:1024
    ds_read_b64_tr_b16 a[44:45], v34 offset:0
    ds_read_b64_tr_b16 a[46:47], v34 offset:1024
    ds_read_b128 a[68:71], v36
    ds_read_b64_tr_b16 a[52:53], v31 offset:4096
    ds_read_b64_tr_b16 a[54:55], v31 offset:5120
    ds_read_b64_tr_b16 a[56:57], v32 offset:4096
    ds_read_b64_tr_b16 a[58:59], v32 offset:5120
    ds_read_b64_tr_b16 a[60:61], v33 offset:4096
    ds_read_b64_tr_b16 a[62:63], v33 offset:5120
    ds_read_b64_tr_b16 a[64:65], v34 offset:4096
    ds_read_b64_tr_b16 a[66:67], v34 offset:5120
    s_waitcnt lgkmcnt(9)
    v_mfma_f32_32x32x16_bf16 v[48:63], a[32:35], a[48:51], v[48:63]
    v_mfma_f32_32x32x16_bf16 v[64:79], a[36:39], a[48:51], v[64:79]
    v_mfma_f32_32x32x16_bf16 v[80:95], a[40:43], a[48:51], v[80:95]
    v_mfma_f32_32x32x16_bf16 v[96:111], a[44:47], a[48:51], v[96:111]
    ds_read_b128 a[48:51], v37
    ds_read_b64_tr_b16 a[32:33], v31 offset:8192
    ds_read_b64_tr_b16 a[34:35], v31 offset:9216
    ds_read_b64_tr_b16 a[36:37], v32 offset:8192
    ds_read_b64_tr_b16 a[38:39], v32 offset:9216
    ds_read_b64_tr_b16 a[40:41], v33 offset:8192
    ds_read_b64_tr_b16 a[42:43], v33 offset:9216
    ds_read_b64_tr_b16 a[44:45], v34 offset:8192
    ds_read_b64_tr_b16 a[46:47], v34 offset:9216
    s_waitcnt lgkmcnt(9)
    v_mfma_f32_32x32x16_bf16 v[48:63], a[52:55], a[68:71], v[48:63]
    v_mfma_f32_32x32x16_bf16 v[64:79], a[56:59], a[68:71], v[64:79]
    v_mfma_f32_32x32x16_bf16 v[80:95], a[60:63], a[68:71], v[80:95]
    v_mfma_f32_32x32x16_bf16 v[96:111], a[64:67], a[68:71], v[96:111]
    ds_read_b128 a[68:71], v38
    ds_read_b64_tr_b16 a[52:53], v31 offset:12288
    ds_read_b64_tr_b16 a[54:55], v31 offset:13312
    ds_read_b64_tr_b16 a[56:57], v32 offset:12288
    ds_read_b64_tr_b16 a[58:59], v32 offset:13312
    ds_read_b64_tr_b16 a[60:61], v33 offset:12288
    ds_read_b64_tr_b16 a[62:63], v33 offset:13312
    ds_read_b64_tr_b16 a[64:65], v34 offset:12288
    ds_read_b64_tr_b16 a[66:67], v34 offset:13312
    s_waitcnt lgkmcnt(9)
    v_mfma_f32_32x32x16_bf16 v[48:63], a[32:35], a[48:51], v[48:63]
    v_mfma_f32_32x32x16_bf16 v[64:79], a[36:39], a[48:51], v[64:79]
    v_mfma_f32_32x32x16_bf16 v[80:95], a[40:43], a[48:51], v[80:95]
    v_mfma_f32_32x32x16_bf16 v[96:111], a[44:47], a[48:51], v[96:111]
    s_waitcnt lgkmcnt(0)
    v_mfma_f32_32x32x16_bf16 v[48:63], a[52:55], a[68:71], v[48:63]
    v_mfma_f32_32x32x16_bf16 v[64:79], a[56:59], a[68:71], v[64:79]
    v_mfma_f32_32x32x16_bf16 v[80:95], a[60:63], a[68:71], v[80:95]
    v_mfma_f32_32x32x16_bf16 v[96:111], a[64:67], a[68:71], v[96:111]
    s_waitcnt vmcnt(16) lgkmcnt(0)
    s_barrier
    s_add_u32 m0, s33, 81920
    s_lshl_b32 s37, s52, 19
    s_add_u32 s37, s37, s42
    s_mov_b32 s36, s37
    buffer_load_dwordx4 v7, s[20:23], s36 offen  lds
    s_add_u32 m0, s33, 82944
    s_mov_b32 s36, s37
    buffer_load_dwordx4 v8, s[20:23], s36 offen  lds
    s_add_u32 m0, s33, 83968
    s_mov_b32 s36, s37
    buffer_load_dwordx4 v9, s[20:23], s36 offen  lds
    s_add_u32 m0, s33, 84992
    s_mov_b32 s36, s37
    buffer_load_dwordx4 v10, s[20:23], s36 offen  lds
    s_add_u32 m0, s33, 98304
    s_lshl_b32 s37, s52, 7
    s_add_u32 s37, s37, s40
    s_mov_b32 s36, s37
    buffer_load_dwordx4 v11, s[8:11], s36 offen  lds
    s_add_u32 m0, s33, 99328
    s_mov_b32 s36, s37
    buffer_load_dwordx4 v12, s[8:11], s36 offen  lds
    s_add_u32 m0, s33, 100352
    s_mov_b32 s36, s37
    buffer_load_dwordx4 v13, s[8:11], s36 offen  lds
    s_add_u32 m0, s33, 101376
    s_mov_b32 s36, s37
    buffer_load_dwordx4 v14, s[8:11], s36 offen  lds
    s_add_u32 s52, s52, 1
    s_cmp_ge_u32 s52, 10
    s_cselect_b32 s52, 0, s52
    v_add_u32 v31, 131072, v19
    v_add_u32 v32, 131072, v20
    v_add_u32 v33, 131072, v21
    v_add_u32 v34, 131072, v22
    v_add_u32 v35, 147456, v15
    v_add_u32 v36, 147456, v16
    v_add_u32 v37, 147456, v17
    v_add_u32 v38, 147456, v18
    ds_read_b128 a[48:51], v35
    ds_read_b64_tr_b16 a[32:33], v31 offset:0
    ds_read_b64_tr_b16 a[34:35], v31 offset:1024
    ds_read_b64_tr_b16 a[36:37], v32 offset:0
    ds_read_b64_tr_b16 a[38:39], v32 offset:1024
    ds_read_b64_tr_b16 a[40:41], v33 offset:0
    ds_read_b64_tr_b16 a[42:43], v33 offset:1024
    ds_read_b64_tr_b16 a[44:45], v34 offset:0
    ds_read_b64_tr_b16 a[46:47], v34 offset:1024
    ds_read_b128 a[68:71], v36
    ds_read_b64_tr_b16 a[52:53], v31 offset:4096
    ds_read_b64_tr_b16 a[54:55], v31 offset:5120
    ds_read_b64_tr_b16 a[56:57], v32 offset:4096
    ds_read_b64_tr_b16 a[58:59], v32 offset:5120
    ds_read_b64_tr_b16 a[60:61], v33 offset:4096
    ds_read_b64_tr_b16 a[62:63], v33 offset:5120
    ds_read_b64_tr_b16 a[64:65], v34 offset:4096
    ds_read_b64_tr_b16 a[66:67], v34 offset:5120
    s_waitcnt lgkmcnt(9)
    v_mfma_f32_32x32x16_bf16 v[48:63], a[32:35], a[48:51], v[48:63]
    v_mfma_f32_32x32x16_bf16 v[64:79], a[36:39], a[48:51], v[64:79]
    v_mfma_f32_32x32x16_bf16 v[80:95], a[40:43], a[48:51], v[80:95]
    v_mfma_f32_32x32x16_bf16 v[96:111], a[44:47], a[48:51], v[96:111]
    ds_read_b128 a[48:51], v37
    ds_read_b64_tr_b16 a[32:33], v31 offset:8192
    ds_read_b64_tr_b16 a[34:35], v31 offset:9216
    ds_read_b64_tr_b16 a[36:37], v32 offset:8192
    ds_read_b64_tr_b16 a[38:39], v32 offset:9216
    ds_read_b64_tr_b16 a[40:41], v33 offset:8192
    ds_read_b64_tr_b16 a[42:43], v33 offset:9216
    ds_read_b64_tr_b16 a[44:45], v34 offset:8192
    ds_read_b64_tr_b16 a[46:47], v34 offset:9216
    s_waitcnt lgkmcnt(9)
    v_mfma_f32_32x32x16_bf16 v[48:63], a[52:55], a[68:71], v[48:63]
    v_mfma_f32_32x32x16_bf16 v[64:79], a[56:59], a[68:71], v[64:79]
    v_mfma_f32_32x32x16_bf16 v[80:95], a[60:63], a[68:71], v[80:95]
    v_mfma_f32_32x32x16_bf16 v[96:111], a[64:67], a[68:71], v[96:111]
    ds_read_b128 a[68:71], v38
    ds_read_b64_tr_b16 a[52:53], v31 offset:12288
    ds_read_b64_tr_b16 a[54:55], v31 offset:13312
    ds_read_b64_tr_b16 a[56:57], v32 offset:12288
    ds_read_b64_tr_b16 a[58:59], v32 offset:13312
    ds_read_b64_tr_b16 a[60:61], v33 offset:12288
    ds_read_b64_tr_b16 a[62:63], v33 offset:13312
    ds_read_b64_tr_b16 a[64:65], v34 offset:12288
    ds_read_b64_tr_b16 a[66:67], v34 offset:13312
    s_waitcnt lgkmcnt(9)
    v_mfma_f32_32x32x16_bf16 v[48:63], a[32:35], a[48:51], v[48:63]
    v_mfma_f32_32x32x16_bf16 v[64:79], a[36:39], a[48:51], v[64:79]
    v_mfma_f32_32x32x16_bf16 v[80:95], a[40:43], a[48:51], v[80:95]
    v_mfma_f32_32x32x16_bf16 v[96:111], a[44:47], a[48:51], v[96:111]
    s_waitcnt lgkmcnt(0)
    v_mfma_f32_32x32x16_bf16 v[48:63], a[52:55], a[68:71], v[48:63]
    v_mfma_f32_32x32x16_bf16 v[64:79], a[56:59], a[68:71], v[64:79]
    v_mfma_f32_32x32x16_bf16 v[80:95], a[60:63], a[68:71], v[80:95]
    v_mfma_f32_32x32x16_bf16 v[96:111], a[64:67], a[68:71], v[96:111]
    s_waitcnt vmcnt(12) lgkmcnt(0)
    s_barrier
    s_add_u32 m0, s33, 131072
    s_mov_b32 s36, 0
    buffer_load_dwordx4 v6, s[16:19], s36 offen nt lds
    s_add_u32 m0, s33, 132096
    s_mov_b32 s36, 1024
    buffer_load_dwordx4 v6, s[16:19], s36 offen nt lds
    s_add_u32 m0, s33, 133120
    s_mov_b32 s36, 2048
    buffer_load_dwordx4 v6, s[16:19], s36 offen nt lds
    s_add_u32 m0, s33, 134144
    s_mov_b32 s36, 3072
    buffer_load_dwordx4 v6, s[16:19], s36 offen nt lds
    s_add_u32 m0, s33, 147456
    s_lshl_b32 s37, s52, 19
    s_add_u32 s37, s37, s42
    s_mov_b32 s36, s37
    buffer_load_dwordx4 v7, s[20:23], s36 offen  lds
    s_add_u32 m0, s33, 148480
    s_mov_b32 s36, s37
    buffer_load_dwordx4 v8, s[20:23], s36 offen  lds
    s_add_u32 m0, s33, 149504
    s_mov_b32 s36, s37
    buffer_load_dwordx4 v9, s[20:23], s36 offen  lds
    s_add_u32 m0, s33, 150528
    s_mov_b32 s36, s37
    buffer_load_dwordx4 v10, s[20:23], s36 offen  lds
    v_add_u32 v31, 16384, v19
    v_add_u32 v32, 16384, v20
    v_add_u32 v33, 16384, v21
    v_add_u32 v34, 16384, v22
    v_add_u32 v35, 32768, v15
    v_add_u32 v36, 32768, v16
    v_add_u32 v37, 32768, v17
    v_add_u32 v38, 32768, v18
    ds_read_b128 a[48:51], v35
    ds_read_b64_tr_b16 a[32:33], v31 offset:0
    ds_read_b64_tr_b16 a[34:35], v31 offset:1024
    ds_read_b64_tr_b16 a[36:37], v32 offset:0
    ds_read_b64_tr_b16 a[38:39], v32 offset:1024
    ds_read_b64_tr_b16 a[40:41], v33 offset:0
    ds_read_b64_tr_b16 a[42:43], v33 offset:1024
    ds_read_b64_tr_b16 a[44:45], v34 offset:0
    ds_read_b64_tr_b16 a[46:47], v34 offset:1024
    ds_read_b128 a[68:71], v36
    ds_read_b64_tr_b16 a[52:53], v31 offset:4096
    ds_read_b64_tr_b16 a[54:55], v31 offset:5120
    ds_read_b64_tr_b16 a[56:57], v32 offset:4096
    ds_read_b64_tr_b16 a[58:59], v32 offset:5120
    ds_read_b64_tr_b16 a[60:61], v33 offset:4096
    ds_read_b64_tr_b16 a[62:63], v33 offset:5120
    ds_read_b64_tr_b16 a[64:65], v34 offset:4096
    ds_read_b64_tr_b16 a[66:67], v34 offset:5120
    s_waitcnt lgkmcnt(9)
    v_mfma_f32_32x32x16_bf16 v[48:63], a[32:35], a[48:51], v[48:63]
    v_mfma_f32_32x32x16_bf16 v[64:79], a[36:39], a[48:51], v[64:79]
    v_mfma_f32_32x32x16_bf16 v[80:95], a[40:43], a[48:51], v[80:95]
    v_mfma_f32_32x32x16_bf16 v[96:111], a[44:47], a[48:51], v[96:111]
    ds_read_b128 a[48:51], v37
    ds_read_b64_tr_b16 a[32:33], v31 offset:8192
    ds_read_b64_tr_b16 a[34:35], v31 offset:9216
    ds_read_b64_tr_b16 a[36:37], v32 offset:8192
    ds_read_b64_tr_b16 a[38:39], v32 offset:9216
    ds_read_b64_tr_b16 a[40:41], v33 offset:8192
    ds_read_b64_tr_b16 a[42:43], v33 offset:9216
    ds_read_b64_tr_b16 a[44:45], v34 offset:8192
    ds_read_b64_tr_b16 a[46:47], v34 offset:9216
    s_waitcnt lgkmcnt(9)
    v_mfma_f32_32x32x16_bf16 v[48:63], a[52:55], a[68:71], v[48:63]
    v_mfma_f32_32x32x16_bf16 v[64:79], a[56:59], a[68:71], v[64:79]
    v_mfma_f32_32x32x16_bf16 v[80:95], a[60:63], a[68:71], v[80:95]
    v_mfma_f32_32x32x16_bf16 v[96:111], a[64:67], a[68:71], v[96:111]
    ds_read_b128 a[68:71], v38
    ds_read_b64_tr_b16 a[52:53], v31 offset:12288
    ds_read_b64_tr_b16 a[54:55], v31 offset:13312
    ds_read_b64_tr_b16 a[56:57], v32 offset:12288
    ds_read_b64_tr_b16 a[58:59], v32 offset:13312
    ds_read_b64_tr_b16 a[60:61], v33 offset:12288
    ds_read_b64_tr_b16 a[62:63], v33 offset:13312
    ds_read_b64_tr_b16 a[64:65], v34 offset:12288
    ds_read_b64_tr_b16 a[66:67], v34 offset:13312
    s_waitcnt lgkmcnt(9)
    v_mfma_f32_32x32x16_bf16 v[48:63], a[32:35], a[48:51], v[48:63]
    v_mfma_f32_32x32x16_bf16 v[64:79], a[36:39], a[48:51], v[64:79]
    v_mfma_f32_32x32x16_bf16 v[80:95], a[40:43], a[48:51], v[80:95]
    v_mfma_f32_32x32x16_bf16 v[96:111], a[44:47], a[48:51], v[96:111]
    s_waitcnt lgkmcnt(0)
    v_mfma_f32_32x32x16_bf16 v[48:63], a[52:55], a[68:71], v[48:63]
    v_mfma_f32_32x32x16_bf16 v[64:79], a[56:59], a[68:71], v[64:79]
    v_mfma_f32_32x32x16_bf16 v[80:95], a[60:63], a[68:71], v[80:95]
    v_mfma_f32_32x32x16_bf16 v[96:111], a[64:67], a[68:71], v[96:111]
    s_waitcnt vmcnt(8) lgkmcnt(0)
    s_barrier
    s_add_u32 m0, s33, 16384
    s_lshl_b32 s37, s52, 7
    s_add_u32 s37, s37, s40
    s_mov_b32 s36, s37
    buffer_load_dwordx4 v11, s[8:11], s36 offen  lds
    s_add_u32 m0, s33, 17408
    s_mov_b32 s36, s37
    buffer_load_dwordx4 v12, s[8:11], s36 offen  lds
    s_add_u32 m0, s33, 18432
    s_mov_b32 s36, s37
    buffer_load_dwordx4 v13, s[8:11], s36 offen  lds
    s_add_u32 m0, s33, 19456
    s_mov_b32 s36, s37
    buffer_load_dwordx4 v14, s[8:11], s36 offen  lds
    s_add_u32 s52, s52, 1
    s_cmp_ge_u32 s52, 10
    s_cselect_b32 s52, 0, s52
    s_add_u32 m0, s33, 32768
    s_mov_b32 s36, 16384
    buffer_load_dwordx4 v6, s[16:19], s36 offen nt lds
    s_add_u32 m0, s33, 33792
    s_mov_b32 s36, 17408
    buffer_load_dwordx4 v6, s[16:19], s36 offen nt lds
    s_add_u32 m0, s33, 34816
    s_mov_b32 s36, 18432
    buffer_load_dwordx4 v6, s[16:19], s36 offen nt lds
    s_add_u32 m0, s33, 35840
    s_mov_b32 s36, 19456
    buffer_load_dwordx4 v6, s[16:19], s36 offen nt lds
    v_add_u32 v31, 81920, v19
    v_add_u32 v32, 81920, v20
    v_add_u32 v33, 81920, v21
    v_add_u32 v34, 81920, v22
    v_add_u32 v35, 98304, v15
    v_add_u32 v36, 98304, v16
    v_add_u32 v37, 98304, v17
    v_add_u32 v38, 98304, v18
    ds_read_b128 a[48:51], v35
    ds_read_b64_tr_b16 a[32:33], v31 offset:0
    ds_read_b64_tr_b16 a[34:35], v31 offset:1024
    ds_read_b64_tr_b16 a[36:37], v32 offset:0
    ds_read_b64_tr_b16 a[38:39], v32 offset:1024
    ds_read_b64_tr_b16 a[40:41], v33 offset:0
    ds_read_b64_tr_b16 a[42:43], v33 offset:1024
    ds_read_b64_tr_b16 a[44:45], v34 offset:0
    ds_read_b64_tr_b16 a[46:47], v34 offset:1024
    ds_read_b128 a[68:71], v36
    ds_read_b64_tr_b16 a[52:53], v31 offset:4096
    ds_read_b64_tr_b16 a[54:55], v31 offset:5120
    ds_read_b64_tr_b16 a[56:57], v32 offset:4096
    ds_read_b64_tr_b16 a[58:59], v32 offset:5120
    ds_read_b64_tr_b16 a[60:61], v33 offset:4096
    ds_read_b64_tr_b16 a[62:63], v33 offset:5120
    ds_read_b64_tr_b16 a[64:65], v34 offset:4096
    ds_read_b64_tr_b16 a[66:67], v34 offset:5120
    s_waitcnt lgkmcnt(9)
    v_mfma_f32_32x32x16_bf16 v[48:63], a[32:35], a[48:51], v[48:63]
    v_mfma_f32_32x32x16_bf16 v[64:79], a[36:39], a[48:51], v[64:79]
    v_mfma_f32_32x32x16_bf16 v[80:95], a[40:43], a[48:51], v[80:95]
    v_mfma_f32_32x32x16_bf16 v[96:111], a[44:47], a[48:51], v[96:111]
    ds_read_b128 a[48:51], v37
    ds_read_b64_tr_b16 a[32:33], v31 offset:8192
    ds_read_b64_tr_b16 a[34:35], v31 offset:9216
    ds_read_b64_tr_b16 a[36:37], v32 offset:8192
    ds_read_b64_tr_b16 a[38:39], v32 offset:9216
    ds_read_b64_tr_b16 a[40:41], v33 offset:8192
    ds_read_b64_tr_b16 a[42:43], v33 offset:9216
    ds_read_b64_tr_b16 a[44:45], v34 offset:8192
    ds_read_b64_tr_b16 a[46:47], v34 offset:9216
    s_waitcnt lgkmcnt(9)
    v_mfma_f32_32x32x16_bf16 v[48:63], a[52:55], a[68:71], v[48:63]
    v_mfma_f32_32x32x16_bf16 v[64:79], a[56:59], a[68:71], v[64:79]
    v_mfma_f32_32x32x16_bf16 v[80:95], a[60:63], a[68:71], v[80:95]
    v_mfma_f32_32x32x16_bf16 v[96:111], a[64:67], a[68:71], v[96:111]
    ds_read_b128 a[68:71], v38
    ds_read_b64_tr_b16 a[52:53], v31 offset:12288
    ds_read_b64_tr_b16 a[54:55], v31 offset:13312
    ds_read_b64_tr_b16 a[56:57], v32 offset:12288
    ds_read_b64_tr_b16 a[58:59], v32 offset:13312
    ds_read_b64_tr_b16 a[60:61], v33 offset:12288
    ds_read_b64_tr_b16 a[62:63], v33 offset:13312
    ds_read_b64_tr_b16 a[64:65], v34 offset:12288
    ds_read_b64_tr_b16 a[66:67], v34 offset:13312
    s_waitcnt lgkmcnt(9)
    v_mfma_f32_32x32x16_bf16 v[48:63], a[32:35], a[48:51], v[48:63]
    v_mfma_f32_32x32x16_bf16 v[64:79], a[36:39], a[48:51], v[64:79]
    v_mfma_f32_32x32x16_bf16 v[80:95], a[40:43], a[48:51], v[80:95]
    v_mfma_f32_32x32x16_bf16 v[96:111], a[44:47], a[48:51], v[96:111]
    s_waitcnt lgkmcnt(0)
    v_mfma_f32_32x32x16_bf16 v[48:63], a[52:55], a[68:71], v[48:63]
    v_mfma_f32_32x32x16_bf16 v[64:79], a[56:59], a[68:71], v[64:79]
    v_mfma_f32_32x32x16_bf16 v[80:95], a[60:63], a[68:71], v[80:95]
    v_mfma_f32_32x32x16_bf16 v[96:111], a[64:67], a[68:71], v[96:111]
    s_waitcnt vmcnt(4) lgkmcnt(0)
    s_barrier
    s_add_u32 m0, s33, 81920
    s_lshl_b32 s37, s52, 19
    s_add_u32 s37, s37, s42
    s_mov_b32 s36, s37
    buffer_load_dwordx4 v7, s[20:23], s36 offen  lds
    s_add_u32 m0, s33, 82944
    s_mov_b32 s36, s37
    buffer_load_dwordx4 v8, s[20:23], s36 offen  lds
    s_add_u32 m0, s33, 83968
    s_mov_b32 s36, s37
    buffer_load_dwordx4 v9, s[20:23], s36 offen  lds
    s_add_u32 m0, s33, 84992
    s_mov_b32 s36, s37
    buffer_load_dwordx4 v10, s[20:23], s36 offen  lds
    s_add_u32 m0, s33, 98304
    s_lshl_b32 s37, s52, 7
    s_add_u32 s37, s37, s40
    s_mov_b32 s36, s37
    buffer_load_dwordx4 v11, s[8:11], s36 offen  lds
    s_add_u32 m0, s33, 99328
    s_mov_b32 s36, s37
    buffer_load_dwordx4 v12, s[8:11], s36 offen  lds
    s_add_u32 m0, s33, 100352
    s_mov_b32 s36, s37
    buffer_load_dwordx4 v13, s[8:11], s36 offen  lds
    s_add_u32 m0, s33, 101376
    s_mov_b32 s36, s37
    buffer_load_dwordx4 v14, s[8:11], s36 offen  lds
    s_add_u32 s52, s52, 1
    s_cmp_ge_u32 s52, 10
    s_cselect_b32 s52, 0, s52
    v_add_u32 v31, 147456, v19
    v_add_u32 v32, 147456, v20
    v_add_u32 v33, 147456, v21
    v_add_u32 v34, 147456, v22
    v_add_u32 v35, 16384, v15
    v_add_u32 v36, 16384, v16
    v_add_u32 v37, 16384, v17
    v_add_u32 v38, 16384, v18
    ds_read_b128 a[48:51], v35
    ds_read_b64_tr_b16 a[32:33], v31 offset:0
    ds_read_b64_tr_b16 a[34:35], v31 offset:1024
    ds_read_b64_tr_b16 a[36:37], v32 offset:0
    ds_read_b64_tr_b16 a[38:39], v32 offset:1024
    ds_read_b64_tr_b16 a[40:41], v33 offset:0
    ds_read_b64_tr_b16 a[42:43], v33 offset:1024
    ds_read_b64_tr_b16 a[44:45], v34 offset:0
    ds_read_b64_tr_b16 a[46:47], v34 offset:1024
    ds_read_b128 a[68:71], v36
    ds_read_b64_tr_b16 a[52:53], v31 offset:4096
    ds_read_b64_tr_b16 a[54:55], v31 offset:5120
    ds_read_b64_tr_b16 a[56:57], v32 offset:4096
    ds_read_b64_tr_b16 a[58:59], v32 offset:5120
    ds_read_b64_tr_b16 a[60:61], v33 offset:4096
    ds_read_b64_tr_b16 a[62:63], v33 offset:5120
    ds_read_b64_tr_b16 a[64:65], v34 offset:4096
    ds_read_b64_tr_b16 a[66:67], v34 offset:5120
    s_waitcnt lgkmcnt(9)
    v_mfma_f32_32x32x16_bf16 v[48:63], a[32:35], a[48:51], v[48:63]
    v_mfma_f32_32x32x16_bf16 v[64:79], a[36:39], a[48:51], v[64:79]
    v_mfma_f32_32x32x16_bf16 v[80:95], a[40:43], a[48:51], v[80:95]
    v_mfma_f32_32x32x16_bf16 v[96:111], a[44:47], a[48:51], v[96:111]
    ds_read_b128 a[48:51], v37
    ds_read_b64_tr_b16 a[32:33], v31 offset:8192
    ds_read_b64_tr_b16 a[34:35], v31 offset:9216
    ds_read_b64_tr_b16 a[36:37], v32 offset:8192
    ds_read_b64_tr_b16 a[38:39], v32 offset:9216
    ds_read_b64_tr_b16 a[40:41], v33 offset:8192
    ds_read_b64_tr_b16 a[42:43], v33 offset:9216
    ds_read_b64_tr_b16 a[44:45], v34 offset:8192
    ds_read_b64_tr_b16 a[46:47], v34 offset:9216
    s_waitcnt lgkmcnt(9)
    v_mfma_f32_32x32x16_bf16 v[48:63], a[52:55], a[68:71], v[48:63]
    v_mfma_f32_32x32x16_bf16 v[64:79], a[56:59], a[68:71], v[64:79]
    v_mfma_f32_32x32x16_bf16 v[80:95], a[60:63], a[68:71], v[80:95]
    v_mfma_f32_32x32x16_bf16 v[96:111], a[64:67], a[68:71], v[96:111]
    ds_read_b128 a[68:71], v38
    ds_read_b64_tr_b16 a[52:53], v31 offset:12288
    ds_read_b64_tr_b16 a[54:55], v31 offset:13312
    ds_read_b64_tr_b16 a[56:57], v32 offset:12288
    ds_read_b64_tr_b16 a[58:59], v32 offset:13312
    ds_read_b64_tr_b16 a[60:61], v33 offset:12288
    ds_read_b64_tr_b16 a[62:63], v33 offset:13312
    ds_read_b64_tr_b16 a[64:65], v34 offset:12288
    ds_read_b64_tr_b16 a[66:67], v34 offset:13312
    s_waitcnt lgkmcnt(9)
    v_mfma_f32_32x32x16_bf16 v[48:63], a[32:35], a[48:51], v[48:63]
    v_mfma_f32_32x32x16_bf16 v[64:79], a[36:39], a[48:51], v[64:79]
    v_mfma_f32_32x32x16_bf16 v[80:95], a[40:43], a[48:51], v[80:95]
    v_mfma_f32_32x32x16_bf16 v[96:111], a[44:47], a[48:51], v[96:111]
    s_waitcnt lgkmcnt(0)
    v_mfma_f32_32x32x16_bf16 v[48:63], a[52:55], a[68:71], v[48:63]
    v_mfma_f32_32x32x16_bf16 v[64:79], a[56:59], a[68:71], v[64:79]
    v_mfma_f32_32x32x16_bf16 v[80:95], a[60:63], a[68:71], v[80:95]
    v_mfma_f32_32x32x16_bf16 v[96:111], a[64:67], a[68:71], v[96:111]
    s_waitcnt vmcnt(0) lgkmcnt(0)
    s_barrier
    s_add_u32 m0, s33, 147456
    s_lshl_b32 s37, s52, 19
    s_add_u32 s37, s37, s42
    s_mov_b32 s36, s37
    buffer_load_dwordx4 v7, s[20:23], s36 offen  lds
    s_add_u32 m0, s33, 148480
    s_mov_b32 s36, s37
    buffer_load_dwordx4 v8, s[20:23], s36 offen  lds
    s_add_u32 m0, s33, 149504
    s_mov_b32 s36, s37
    buffer_load_dwordx4 v9, s[20:23], s36 offen  lds
    s_add_u32 m0, s33, 150528
    s_mov_b32 s36, s37
    buffer_load_dwordx4 v10, s[20:23], s36 offen  lds
    s_add_u32 m0, s33, 16384
    s_lshl_b32 s37, s52, 7
    s_add_u32 s37, s37, s40
    s_mov_b32 s36, s37
    buffer_load_dwordx4 v11, s[8:11], s36 offen  lds
    s_add_u32 m0, s33, 17408
    s_mov_b32 s36, s37
    buffer_load_dwordx4 v12, s[8:11], s36 offen  lds
    s_add_u32 m0, s33, 18432
    s_mov_b32 s36, s37
    buffer_load_dwordx4 v13, s[8:11], s36 offen  lds
    s_add_u32 m0, s33, 19456
    s_mov_b32 s36, s37
    buffer_load_dwordx4 v14, s[8:11], s36 offen  lds
    s_add_u32 s52, s52, 1
    s_cmp_ge_u32 s52, 10
    s_cselect_b32 s52, 0, s52
    v_add_u32 v31, 81920, v19
    v_add_u32 v32, 81920, v20
    v_add_u32 v33, 81920, v21
    v_add_u32 v34, 81920, v22
    v_add_u32 v35, 98304, v15
    v_add_u32 v36, 98304, v16
    v_add_u32 v37, 98304, v17
    v_add_u32 v38, 98304, v18
    ds_read_b128 a[48:51], v35
    ds_read_b64_tr_b16 a[32:33], v31 offset:0
    ds_read_b64_tr_b16 a[34:35], v31 offset:1024
    ds_read_b64_tr_b16 a[36:37], v32 offset:0
    ds_read_b64_tr_b16 a[38:39], v32 offset:1024
    ds_read_b64_tr_b16 a[40:41], v33 offset:0
    ds_read_b64_tr_b16 a[42:43], v33 offset:1024
    ds_read_b64_tr_b16 a[44:45], v34 offset:0
    ds_read_b64_tr_b16 a[46:47], v34 offset:1024
    ds_read_b128 a[68:71], v36
    ds_read_b64_tr_b16 a[52:53], v31 offset:4096
    ds_read_b64_tr_b16 a[54:55], v31 offset:5120
    ds_read_b64_tr_b16 a[56:57], v32 offset:4096
    ds_read_b64_tr_b16 a[58:59], v32 offset:5120
    ds_read_b64_tr_b16 a[60:61], v33 offset:4096
    ds_read_b64_tr_b16 a[62:63], v33 offset:5120
    ds_read_b64_tr_b16 a[64:65], v34 offset:4096
    ds_read_b64_tr_b16 a[66:67], v34 offset:5120
    s_waitcnt lgkmcnt(9)
    v_mfma_f32_32x32x16_bf16 v[48:63], a[32:35], a[48:51], v[48:63]
    v_mfma_f32_32x32x16_bf16 v[64:79], a[36:39], a[48:51], v[64:79]
    v_mfma_f32_32x32x16_bf16 v[80:95], a[40:43], a[48:51], v[80:95]
    v_mfma_f32_32x32x16_bf16 v[96:111], a[44:47], a[48:51], v[96:111]
    ds_read_b128 a[48:51], v37
    ds_read_b64_tr_b16 a[32:33], v31 offset:8192
    ds_read_b64_tr_b16 a[34:35], v31 offset:9216
    ds_read_b64_tr_b16 a[36:37], v32 offset:8192
    ds_read_b64_tr_b16 a[38:39], v32 offset:9216
    ds_read_b64_tr_b16 a[40:41], v33 offset:8192
    ds_read_b64_tr_b16 a[42:43], v33 offset:9216
    ds_read_b64_tr_b16 a[44:45], v34 offset:8192
    ds_read_b64_tr_b16 a[46:47], v34 offset:9216
    s_waitcnt lgkmcnt(9)
    v_mfma_f32_32x32x16_bf16 v[48:63], a[52:55], a[68:71], v[48:63]
    v_mfma_f32_32x32x16_bf16 v[64:79], a[56:59], a[68:71], v[64:79]
    v_mfma_f32_32x32x16_bf16 v[80:95], a[60:63], a[68:71], v[80:95]
    v_mfma_f32_32x32x16_bf16 v[96:111], a[64:67], a[68:71], v[96:111]
    ds_read_b128 a[68:71], v38
    ds_read_b64_tr_b16 a[52:53], v31 offset:12288
    ds_read_b64_tr_b16 a[54:55], v31 offset:13312
    ds_read_b64_tr_b16 a[56:57], v32 offset:12288
    ds_read_b64_tr_b16 a[58:59], v32 offset:13312
    ds_read_b64_tr_b16 a[60:61], v33 offset:12288
    ds_read_b64_tr_b16 a[62:63], v33 offset:13312
    ds_read_b64_tr_b16 a[64:65], v34 offset:12288
    ds_read_b64_tr_b16 a[66:67], v34 offset:13312
    s_waitcnt lgkmcnt(9)
    v_mfma_f32_32x32x16_bf16 v[48:63], a[32:35], a[48:51], v[48:63]
    v_mfma_f32_32x32x16_bf16 v[64:79], a[36:39], a[48:51], v[64:79]
    v_mfma_f32_32x32x16_bf16 v[80:95], a[40:43], a[48:51], v[80:95]
    v_mfma_f32_32x32x16_bf16 v[96:111], a[44:47], a[48:51], v[96:111]
    s_waitcnt lgkmcnt(0)
    v_mfma_f32_32x32x16_bf16 v[48:63], a[52:55], a[68:71], v[48:63]
    v_mfma_f32_32x32x16_bf16 v[64:79], a[56:59], a[68:71], v[64:79]
    v_mfma_f32_32x32x16_bf16 v[80:95], a[60:63], a[68:71], v[80:95]
    v_mfma_f32_32x32x16_bf16 v[96:111], a[64:67], a[68:71], v[96:111]
    s_waitcnt vmcnt(0) lgkmcnt(0)
    s_barrier
    s_add_u32 m0, s33, 81920
    s_lshl_b32 s37, s52, 19
    s_add_u32 s37, s37, s42
    s_mov_b32 s36, s37
    buffer_load_dwordx4 v7, s[20:23], s36 offen  lds
    s_add_u32 m0, s33, 82944
    s_mov_b32 s36, s37
    buffer_load_dwordx4 v8, s[20:23], s36 offen  lds
    s_add_u32 m0, s33, 83968
    s_mov_b32 s36, s37
    buffer_load_dwordx4 v9, s[20:23], s36 offen  lds
    s_add_u32 m0, s33, 84992
    s_mov_b32 s36, s37
    buffer_load_dwordx4 v10, s[20:23], s36 offen  lds
    s_add_u32 m0, s33, 98304
    s_lshl_b32 s37, s52, 7
    s_add_u32 s37, s37, s40
    s_mov_b32 s36, s37
    buffer_load_dwordx4 v11, s[8:11], s36 offen  lds
    s_add_u32 m0, s33, 99328
    s_mov_b32 s36, s37
    buffer_load_dwordx4 v12, s[8:11], s36 offen  lds
    s_add_u32 m0, s33, 100352
    s_mov_b32 s36, s37
    buffer_load_dwordx4 v13, s[8:11], s36 offen  lds
    s_add_u32 m0, s33, 101376
    s_mov_b32 s36, s37
    buffer_load_dwordx4 v14, s[8:11], s36 offen  lds
    s_add_u32 s52, s52, 1
    s_cmp_ge_u32 s52, 10
    s_cselect_b32 s52, 0, s52
    v_add_u32 v31, 147456, v19
    v_add_u32 v32, 147456, v20
    v_add_u32 v33, 147456, v21
    v_add_u32 v34, 147456, v22
    v_add_u32 v35, 16384, v15
    v_add_u32 v36, 16384, v16
    v_add_u32 v37, 16384, v17
    v_add_u32 v38, 16384, v18
    ds_read_b128 a[48:51], v35
    ds_read_b64_tr_b16 a[32:33], v31 offset:0
    ds_read_b64_tr_b16 a[34:35], v31 offset:1024
    ds_read_b64_tr_b16 a[36:37], v32 offset:0
    ds_read_b64_tr_b16 a[38:39], v32 offset:1024
    ds_read_b64_tr_b16 a[40:41], v33 offset:0
    ds_read_b64_tr_b16 a[42:43], v33 offset:1024
    ds_read_b64_tr_b16 a[44:45], v34 offset:0
    ds_read_b64_tr_b16 a[46:47], v34 offset:1024
    ds_read_b128 a[68:71], v36
    ds_read_b64_tr_b16 a[52:53], v31 offset:4096
    ds_read_b64_tr_b16 a[54:55], v31 offset:5120
    ds_read_b64_tr_b16 a[56:57], v32 offset:4096
    ds_read_b64_tr_b16 a[58:59], v32 offset:5120
    ds_read_b64_tr_b16 a[60:61], v33 offset:4096
    ds_read_b64_tr_b16 a[62:63], v33 offset:5120
    ds_read_b64_tr_b16 a[64:65], v34 offset:4096
    ds_read_b64_tr_b16 a[66:67], v34 offset:5120
    s_waitcnt lgkmcnt(9)
    v_mfma_f32_32x32x16_bf16 v[48:63], a[32:35], a[48:51], v[48:63]
    v_mfma_f32_32x32x16_bf16 v[64:79], a[36:39], a[48:51], v[64:79]
    v_mfma_f32_32x32x16_bf16 v[80:95], a[40:43], a[48:51], v[80:95]
    v_mfma_f32_32x32x16_bf16 v[96:111], a[44:47], a[48:51], v[96:111]
    ds_read_b128 a[48:51], v37
    ds_read_b64_tr_b16 a[32:33], v31 offset:8192
    ds_read_b64_tr_b16 a[34:35], v31 offset:9216
    ds_read_b64_tr_b16 a[36:37], v32 offset:8192
    ds_read_b64_tr_b16 a[38:39], v32 offset:9216
    ds_read_b64_tr_b16 a[40:41], v33 offset:8192
    ds_read_b64_tr_b16 a[42:43], v33 offset:9216
    ds_read_b64_tr_b16 a[44:45], v34 offset:8192
    ds_read_b64_tr_b16 a[46:47], v34 offset:9216
    s_waitcnt lgkmcnt(9)
    v_mfma_f32_32x32x16_bf16 v[48:63], a[52:55], a[68:71], v[48:63]
    v_mfma_f32_32x32x16_bf16 v[64:79], a[56:59], a[68:71], v[64:79]
    v_mfma_f32_32x32x16_bf16 v[80:95], a[60:63], a[68:71], v[80:95]
    v_mfma_f32_32x32x16_bf16 v[96:111], a[64:67], a[68:71], v[96:111]
    ds_read_b128 a[68:71], v38
    ds_read_b64_tr_b16 a[52:53], v31 offset:12288
    ds_read_b64_tr_b16 a[54:55], v31 offset:13312
    ds_read_b64_tr_b16 a[56:57], v32 offset:12288
    ds_read_b64_tr_b16 a[58:59], v32 offset:13312
    ds_read_b64_tr_b16 a[60:61], v33 offset:12288
    ds_read_b64_tr_b16 a[62:63], v33 offset:13312
    ds_read_b64_tr_b16 a[64:65], v34 offset:12288
    ds_read_b64_tr_b16 a[66:67], v34 offset:13312
    s_waitcnt lgkmcnt(9)
    v_mfma_f32_32x32x16_bf16 v[48:63], a[32:35], a[48:51], v[48:63]
    v_mfma_f32_32x32x16_bf16 v[64:79], a[36:39], a[48:51], v[64:79]
    v_mfma_f32_32x32x16_bf16 v[80:95], a[40:43], a[48:51], v[80:95]
    v_mfma_f32_32x32x16_bf16 v[96:111], a[44:47], a[48:51], v[96:111]
    s_waitcnt lgkmcnt(0)
    v_mfma_f32_32x32x16_bf16 v[48:63], a[52:55], a[68:71], v[48:63]
    v_mfma_f32_32x32x16_bf16 v[64:79], a[56:59], a[68:71], v[64:79]
    v_mfma_f32_32x32x16_bf16 v[80:95], a[60:63], a[68:71], v[80:95]
    v_mfma_f32_32x32x16_bf16 v[96:111], a[64:67], a[68:71], v[96:111]
    s_waitcnt vmcnt(0) lgkmcnt(0)
    s_barrier
    s_add_u32 m0, s33, 147456
    s_mov_b32 s36, 65536
    buffer_load_dwordx4 v2, s[12:15], s36 offen nt lds
    s_add_u32 m0, s33, 148480
    s_mov_b32 s36, 65536
    buffer_load_dwordx4 v3, s[12:15], s36 offen nt lds
    s_add_u32 m0, s33, 149504
    s_mov_b32 s36, 65536
    buffer_load_dwordx4 v4, s[12:15], s36 offen nt lds
    s_add_u32 m0, s33, 150528
    s_mov_b32 s36, 65536
    buffer_load_dwordx4 v5, s[12:15], s36 offen nt lds
    s_add_u32 m0, s33, 16384
    s_mov_b32 s36, 81920
    buffer_load_dwordx4 v2, s[12:15], s36 offen nt lds
    s_add_u32 m0, s33, 17408
    s_mov_b32 s36, 81920
    buffer_load_dwordx4 v3, s[12:15], s36 offen nt lds
    s_add_u32 m0, s33, 18432
    s_mov_b32 s36, 81920
    buffer_load_dwordx4 v4, s[12:15], s36 offen nt lds
    s_add_u32 m0, s33, 19456
    s_mov_b32 s36, 81920
    buffer_load_dwordx4 v5, s[12:15], s36 offen nt lds
    v_add_u32 v31, 81920, v19
    v_add_u32 v32, 81920, v20
    v_add_u32 v33, 81920, v21
    v_add_u32 v34, 81920, v22
    v_add_u32 v35, 98304, v15
    v_add_u32 v36, 98304, v16
    v_add_u32 v37, 98304, v17
    v_add_u32 v38, 98304, v18
    ds_read_b128 a[48:51], v35
    ds_read_b64_tr_b16 a[32:33], v31 offset:0
    ds_read_b64_tr_b16 a[34:35], v31 offset:1024
    ds_read_b64_tr_b16 a[36:37], v32 offset:0
    ds_read_b64_tr_b16 a[38:39], v32 offset:1024
    ds_read_b64_tr_b16 a[40:41], v33 offset:0
    ds_read_b64_tr_b16 a[42:43], v33 offset:1024
    ds_read_b64_tr_b16 a[44:45], v34 offset:0
    ds_read_b64_tr_b16 a[46:47], v34 offset:1024
    ds_read_b128 a[68:71], v36
    ds_read_b64_tr_b16 a[52:53], v31 offset:4096
    ds_read_b64_tr_b16 a[54:55], v31 offset:5120
    ds_read_b64_tr_b16 a[56:57], v32 offset:4096
    ds_read_b64_tr_b16 a[58:59], v32 offset:5120
    ds_read_b64_tr_b16 a[60:61], v33 offset:4096
    ds_read_b64_tr_b16 a[62:63], v33 offset:5120
    ds_read_b64_tr_b16 a[64:65], v34 offset:4096
    ds_read_b64_tr_b16 a[66:67], v34 offset:5120
    s_waitcnt lgkmcnt(9)
    v_mfma_f32_32x32x16_bf16 v[48:63], a[32:35], a[48:51], v[48:63]
    v_mfma_f32_32x32x16_bf16 v[64:79], a[36:39], a[48:51], v[64:79]
    v_mfma_f32_32x32x16_bf16 v[80:95], a[40:43], a[48:51], v[80:95]
    v_mfma_f32_32x32x16_bf16 v[96:111], a[44:47], a[48:51], v[96:111]
    ds_read_b128 a[48:51], v37
    ds_read_b64_tr_b16 a[32:33], v31 offset:8192
    ds_read_b64_tr_b16 a[34:35], v31 offset:9216
    ds_read_b64_tr_b16 a[36:37], v32 offset:8192
    ds_read_b64_tr_b16 a[38:39], v32 offset:9216
    ds_read_b64_tr_b16 a[40:41], v33 offset:8192
    ds_read_b64_tr_b16 a[42:43], v33 offset:9216
    ds_read_b64_tr_b16 a[44:45], v34 offset:8192
    ds_read_b64_tr_b16 a[46:47], v34 offset:9216
    s_waitcnt lgkmcnt(9)
    v_mfma_f32_32x32x16_bf16 v[48:63], a[52:55], a[68:71], v[48:63]
    v_mfma_f32_32x32x16_bf16 v[64:79], a[56:59], a[68:71], v[64:79]
    v_mfma_f32_32x32x16_bf16 v[80:95], a[60:63], a[68:71], v[80:95]
    v_mfma_f32_32x32x16_bf16 v[96:111], a[64:67], a[68:71], v[96:111]
    ds_read_b128 a[68:71], v38
    ds_read_b64_tr_b16 a[52:53], v31 offset:12288
    ds_read_b64_tr_b16 a[54:55], v31 offset:13312
    ds_read_b64_tr_b16 a[56:57], v32 offset:12288
    ds_read_b64_tr_b16 a[58:59], v32 offset:13312
    ds_read_b64_tr_b16 a[60:61], v33 offset:12288
    ds_read_b64_tr_b16 a[62:63], v33 offset:13312
    ds_read_b64_tr_b16 a[64:65], v34 offset:12288
    ds_read_b64_tr_b16 a[66:67], v34 offset:13312
    s_waitcnt lgkmcnt(9)
    v_mfma_f32_32x32x16_bf16 v[48:63], a[32:35], a[48:51], v[48:63]
    v_mfma_f32_32x32x16_bf16 v[64:79], a[36:39], a[48:51], v[64:79]
    v_mfma_f32_32x32x16_bf16 v[80:95], a[40:43], a[48:51], v[80:95]
    v_mfma_f32_32x32x16_bf16 v[96:111], a[44:47], a[48:51], v[96:111]
    s_waitcnt lgkmcnt(0)
    v_mfma_f32_32x32x16_bf16 v[48:63], a[52:55], a[68:71], v[48:63]
    v_mfma_f32_32x32x16_bf16 v[64:79], a[56:59], a[68:71], v[64:79]
    v_mfma_f32_32x32x16_bf16 v[80:95], a[60:63], a[68:71], v[80:95]
    v_mfma_f32_32x32x16_bf16 v[96:111], a[64:67], a[68:71], v[96:111]
    s_nop 11
    v_cvt_pk_bf16_f32 v43, v48, v49
    v_accvgpr_write_b32 a0, v43
    v_cvt_pk_bf16_f32 v44, v50, v51
    v_accvgpr_write_b32 a1, v44
    v_cvt_pk_bf16_f32 v43, v52, v53
    v_accvgpr_write_b32 a2, v43
    v_cvt_pk_bf16_f32 v44, v54, v55
    v_accvgpr_write_b32 a3, v44
    v_cvt_pk_bf16_f32 v43, v56, v57
    v_accvgpr_write_b32 a4, v43
    v_cvt_pk_bf16_f32 v44, v58, v59
    v_accvgpr_write_b32 a5, v44
    v_cvt_pk_bf16_f32 v43, v60, v61
    v_accvgpr_write_b32 a6, v43
    v_cvt_pk_bf16_f32 v44, v62, v63
    v_accvgpr_write_b32 a7, v44
    v_cvt_pk_bf16_f32 v43, v64, v65
    v_accvgpr_write_b32 a8, v43
    v_cvt_pk_bf16_f32 v44, v66, v67
    v_accvgpr_write_b32 a9, v44
    v_cvt_pk_bf16_f32 v43, v68, v69
    v_accvgpr_write_b32 a10, v43
    v_cvt_pk_bf16_f32 v44, v70, v71
    v_accvgpr_write_b32 a11, v44
    v_cvt_pk_bf16_f32 v43, v72, v73
    v_accvgpr_write_b32 a12, v43
    v_cvt_pk_bf16_f32 v44, v74, v75
    v_accvgpr_write_b32 a13, v44
    v_cvt_pk_bf16_f32 v43, v76, v77
    v_accvgpr_write_b32 a14, v43
    v_cvt_pk_bf16_f32 v44, v78, v79
    v_accvgpr_write_b32 a15, v44
    v_cvt_pk_bf16_f32 v43, v80, v81
    v_accvgpr_write_b32 a16, v43
    v_cvt_pk_bf16_f32 v44, v82, v83
    v_accvgpr_write_b32 a17, v44
    v_cvt_pk_bf16_f32 v43, v84, v85
    v_accvgpr_write_b32 a18, v43
    v_cvt_pk_bf16_f32 v44, v86, v87
    v_accvgpr_write_b32 a19, v44
    v_cvt_pk_bf16_f32 v43, v88, v89
    v_accvgpr_write_b32 a20, v43
    v_cvt_pk_bf16_f32 v44, v90, v91
    v_accvgpr_write_b32 a21, v44
    v_cvt_pk_bf16_f32 v43, v92, v93
    v_accvgpr_write_b32 a22, v43
    v_cvt_pk_bf16_f32 v44, v94, v95
    v_accvgpr_write_b32 a23, v44
    v_cvt_pk_bf16_f32 v43, v96, v97
    v_accvgpr_write_b32 a24, v43
    v_cvt_pk_bf16_f32 v44, v98, v99
    v_accvgpr_write_b32 a25, v44
    v_cvt_pk_bf16_f32 v43, v100, v101
    v_accvgpr_write_b32 a26, v43
    v_cvt_pk_bf16_f32 v44, v102, v103
    v_accvgpr_write_b32 a27, v44
    v_cvt_pk_bf16_f32 v43, v104, v105
    v_accvgpr_write_b32 a28, v43
    v_cvt_pk_bf16_f32 v44, v106, v107
    v_accvgpr_write_b32 a29, v44
    v_cvt_pk_bf16_f32 v43, v108, v109
    v_accvgpr_write_b32 a30, v43
    v_cvt_pk_bf16_f32 v44, v110, v111
    v_accvgpr_write_b32 a31, v44
    s_nop 1
    s_waitcnt vmcnt(56) lgkmcnt(0)
    s_barrier
    s_add_u32 m0, s33, 81920
    s_mov_b32 s36, 32768
    buffer_load_dwordx4 v6, s[16:19], s36 offen nt lds
    s_add_u32 m0, s33, 82944
    s_mov_b32 s36, 33792
    buffer_load_dwordx4 v6, s[16:19], s36 offen nt lds
    s_add_u32 m0, s33, 83968
    s_mov_b32 s36, 34816
    buffer_load_dwordx4 v6, s[16:19], s36 offen nt lds
    s_add_u32 m0, s33, 84992
    s_mov_b32 s36, 35840
    buffer_load_dwordx4 v6, s[16:19], s36 offen nt lds
    s_add_u32 m0, s33, 98304
    s_mov_b32 s36, 49152
    buffer_load_dwordx4 v6, s[16:19], s36 offen nt lds
    s_add_u32 m0, s33, 99328
    s_mov_b32 s36, 50176
    buffer_load_dwordx4 v6, s[16:19], s36 offen nt lds
    s_add_u32 m0, s33, 100352
    s_mov_b32 s36, 51200
    buffer_load_dwordx4 v6, s[16:19], s36 offen nt lds
    s_add_u32 m0, s33, 101376
    s_mov_b32 s36, 52224
    buffer_load_dwordx4 v6, s[16:19], s36 offen nt lds
    v_add_u32 v31, 65536, v23
    v_add_u32 v32, 65536, v24
    v_add_u32 v33, 65536, v25
    v_add_u32 v34, 65536, v26
    v_add_u32 v35, 65536, v27
    v_add_u32 v36, 65536, v28
    v_add_u32 v37, 65536, v29
    v_add_u32 v38, 65536, v30
    ds_read_b128 a[32:35], v31 offset:0
    ds_read_b128 a[36:39], v32 offset:0
    ds_read_b128 a[40:43], v33 offset:0
    ds_read_b128 a[44:47], v34 offset:0
    ds_read_b128 a[48:51], v35 offset:0
    ds_read_b128 a[52:55], v36 offset:0
    ds_read_b128 a[56:59], v37 offset:0
    s_waitcnt lgkmcnt(5)
    v_mfma_f32_32x32x16_bf16 v[112:127], a[32:35], a[0:3], 0
    ds_read_b128 a[60:63], v38 offset:0
    v_mfma_f32_32x32x16_bf16 v[112:127], a[36:39], a[4:7], v[112:127]
    ds_read_b128 a[64:67], v31 offset:8192
    s_waitcnt lgkmcnt(5)
    v_mfma_f32_32x32x16_bf16 v[112:127], a[40:43], a[8:11], v[112:127]
    ds_read_b128 a[68:71], v32 offset:8192
    v_mfma_f32_32x32x16_bf16 v[112:127], a[44:47], a[12:15], v[112:127]
    ds_read_b128 a[72:75], v33 offset:8192
    s_waitcnt lgkmcnt(5)
    v_mfma_f32_32x32x16_bf16 v[112:127], a[48:51], a[16:19], v[112:127]
    ds_read_b128 a[76:79], v34 offset:8192
    v_mfma_f32_32x32x16_bf16 v[112:127], a[52:55], a[20:23], v[112:127]
    ds_read_b128 a[80:83], v35 offset:8192
    s_waitcnt lgkmcnt(5)
    v_mfma_f32_32x32x16_bf16 v[112:127], a[56:59], a[24:27], v[112:127]
    ds_read_b128 a[84:87], v36 offset:8192
    v_mfma_f32_32x32x16_bf16 v[112:127], a[60:63], a[28:31], v[112:127]
    ds_read_b128 a[88:91], v37 offset:8192
    s_waitcnt lgkmcnt(5)
    v_mfma_f32_32x32x16_bf16 v[128:143], a[64:67], a[0:3], 0
    ds_read_b128 a[92:95], v38 offset:8192
    v_mfma_f32_32x32x16_bf16 v[128:143], a[68:71], a[4:7], v[128:143]
    v_add_u32 v248, 114688, v23
    v_add_u32 v249, 114688, v24
    v_add_u32 v250, 114688, v25
    v_add_u32 v251, 114688, v26
    v_add_u32 v252, 114688, v27
    v_add_u32 v253, 114688, v28
    v_add_u32 v254, 114688, v29
    v_add_u32 v255, 114688, v30
    ds_read_b128 a[32:35], v248 offset:0
    s_waitcnt lgkmcnt(5)
    v_mfma_f32_32x32x16_bf16 v[128:143], a[72:75], a[8:11], v[128:143]
    ds_read_b128 a[36:39], v249 offset:0
    v_mfma_f32_32x32x16_bf16 v[128:143], a[76:79], a[12:15], v[128:143]
    ds_read_b128 a[40:43], v250 offset:0
    s_waitcnt lgkmcnt(5)
    v_mfma_f32_32x32x16_bf16 v[128:143], a[80:83], a[16:19], v[128:143]
    ds_read_b128 a[44:47], v251 offset:0
    v_mfma_f32_32x32x16_bf16 v[128:143], a[84:87], a[20:23], v[128:143]
    ds_read_b128 a[48:51], v252 offset:0
    s_waitcnt lgkmcnt(5)
    v_mfma_f32_32x32x16_bf16 v[128:143], a[88:91], a[24:27], v[128:143]
    ds_read_b128 a[52:55], v253 offset:0
    v_mfma_f32_32x32x16_bf16 v[128:143], a[92:95], a[28:31], v[128:143]
    ds_read_b128 a[56:59], v254 offset:0
    s_waitcnt lgkmcnt(5)
    v_mfma_f32_32x32x16_bf16 v[144:159], a[32:35], a[0:3], 0
    ds_read_b128 a[60:63], v255 offset:0
    v_mfma_f32_32x32x16_bf16 v[144:159], a[36:39], a[4:7], v[144:159]
    ds_read_b128 a[64:67], v248 offset:8192
    s_waitcnt lgkmcnt(5)
    v_mfma_f32_32x32x16_bf16 v[144:159], a[40:43], a[8:11], v[144:159]
    ds_read_b128 a[68:71], v249 offset:8192
    v_mfma_f32_32x32x16_bf16 v[144:159], a[44:47], a[12:15], v[144:159]
    ds_read_b128 a[72:75], v250 offset:8192
    s_waitcnt lgkmcnt(5)
    v_mfma_f32_32x32x16_bf16 v[144:159], a[48:51], a[16:19], v[144:159]
    ds_read_b128 a[76:79], v251 offset:8192
    v_mfma_f32_32x32x16_bf16 v[144:159], a[52:55], a[20:23], v[144:159]
    ds_read_b128 a[80:83], v252 offset:8192
    s_waitcnt lgkmcnt(5)
    v_mfma_f32_32x32x16_bf16 v[144:159], a[56:59], a[24:27], v[144:159]
    ds_read_b128 a[84:87], v253 offset:8192
    v_mfma_f32_32x32x16_bf16 v[144:159], a[60:63], a[28:31], v[144:159]
    ds_read_b128 a[88:91], v254 offset:8192
    s_waitcnt lgkmcnt(5)
    v_mfma_f32_32x32x16_bf16 v[160:175], a[64:67], a[0:3], 0
    ds_read_b128 a[92:95], v255 offset:8192
    v_mfma_f32_32x32x16_bf16 v[160:175], a[68:71], a[4:7], v[160:175]
    v_add_u32 v31, 0, v23
    v_add_u32 v32, 0, v24
    v_add_u32 v33, 0, v25
    v_add_u32 v34, 0, v26
    v_add_u32 v35, 0, v27
    v_add_u32 v36, 0, v28
    v_add_u32 v37, 0, v29
    v_add_u32 v38, 0, v30
    ds_read_b128 a[32:35], v31 offset:0
    s_waitcnt lgkmcnt(5)
    v_mfma_f32_32x32x16_bf16 v[160:175], a[72:75], a[8:11], v[160:175]
    ds_read_b128 a[36:39], v32 offset:0
    v_mfma_f32_32x32x16_bf16 v[160:175], a[76:79], a[12:15], v[160:175]
    ds_read_b128 a[40:43], v33 offset:0
    s_waitcnt lgkmcnt(5)
    v_mfma_f32_32x32x16_bf16 v[160:175], a[80:83], a[16:19], v[160:175]
    ds_read_b128 a[44:47], v34 offset:0
    v_mfma_f32_32x32x16_bf16 v[160:175], a[84:87], a[20:23], v[160:175]
    ds_read_b128 a[48:51], v35 offset:0
    s_waitcnt lgkmcnt(5)
    v_mfma_f32_32x32x16_bf16 v[160:175], a[88:91], a[24:27], v[160:175]
    ds_read_b128 a[52:55], v36 offset:0
    v_mfma_f32_32x32x16_bf16 v[160:175], a[92:95], a[28:31], v[160:175]
    ds_read_b128 a[56:59], v37 offset:0
    s_waitcnt lgkmcnt(5)
    v_mfma_f32_32x32x16_bf16 v[176:191], a[32:35], a[0:3], 0
    v_max3_f32 v43, v112, v113, v114
    v_max3_f32 v43, v43, v115, v116
    v_max3_f32 v43, v43, v117, v118
    v_max3_f32 v43, v43, v119, v120
    v_max3_f32 v43, v43, v121, v122
    v_max3_f32 v43, v43, v123, v124
    v_max3_f32 v43, v43, v125, v126
    v_max_f32 v43, v43, v127
    v_max3_f32 v44, v128, v129, v130
    ds_read_b128 a[60:63], v38 offset:0
    v_mfma_f32_32x32x16_bf16 v[176:191], a[36:39], a[4:7], v[176:191]
    v_max3_f32 v44, v44, v131, v132
    v_max3_f32 v44, v44, v133, v134
    v_max3_f32 v44, v44, v135, v136
    v_max3_f32 v44, v44, v137, v138
    v_max3_f32 v44, v44, v139, v140
    v_max3_f32 v44, v44, v141, v142
    v_max_f32 v44, v44, v143
    v_max3_f32 v45, v144, v145, v146
    v_max3_f32 v45, v45, v147, v148
    ds_read_b128 a[64:67], v31 offset:8192
    s_waitcnt lgkmcnt(5)
    v_mfma_f32_32x32x16_bf16 v[176:191], a[40:43], a[8:11], v[176:191]
    v_max3_f32 v45, v45, v149, v150
    v_max3_f32 v45, v45, v151, v152
    v_max3_f32 v45, v45, v153, v154
    v_max3_f32 v45, v45, v155, v156
    v_max3_f32 v45, v45, v157, v158
    v_max_f32 v45, v45, v159
    v_max3_f32 v46, v160, v161, v162
    v_max3_f32 v46, v46, v163, v164
    v_max3_f32 v46, v46, v165, v166
    ds_read_b128 a[68:71], v32 offset:8192
    v_mfma_f32_32x32x16_bf16 v[176:191], a[44:47], a[12:15], v[176:191]
    v_max3_f32 v46, v46, v167, v168
    v_max3_f32 v46, v46, v169, v170
    v_max3_f32 v46, v46, v171, v172
    v_max3_f32 v46, v46, v173, v174
    v_max_f32 v46, v46, v175
    v_max3_f32 v43, v43, v44, v45
    v_max_f32 v43, v43, v46
    v_mov_b32 v44, v43
    s_nop 1
    ds_read_b128 a[72:75], v33 offset:8192
    s_waitcnt lgkmcnt(5)
    v_mfma_f32_32x32x16_bf16 v[176:191], a[48:51], a[16:19], v[176:191]
    v_permlane32_swap_b32 v43, v44
    v_max_f32 v43, v43, v44
    v_mov_b32 v39, v43
    v_mov_b32 v40, 0
    v_mov_b32 v0, 0
    v_mul_f32 v41, s41, v39
    v_fma_f32 v112, v112, s41, -v41
    v_fma_f32 v113, v113, s41, -v41
    v_fma_f32 v114, v114, s41, -v41
    ds_read_b128 a[76:79], v34 offset:8192
    v_mfma_f32_32x32x16_bf16 v[176:191], a[52:55], a[20:23], v[176:191]
    v_fma_f32 v115, v115, s41, -v41
    v_fma_f32 v116, v116, s41, -v41
    v_fma_f32 v117, v117, s41, -v41
    v_fma_f32 v118, v118, s41, -v41
    v_fma_f32 v119, v119, s41, -v41
    v_fma_f32 v120, v120, s41, -v41
    v_fma_f32 v121, v121, s41, -v41
    v_fma_f32 v122, v122, s41, -v41
    v_fma_f32 v123, v123, s41, -v41
    ds_read_b128 a[80:83], v35 offset:8192
    s_waitcnt lgkmcnt(5)
    v_mfma_f32_32x32x16_bf16 v[176:191], a[56:59], a[24:27], v[176:191]
    v_fma_f32 v124, v124, s41, -v41
    v_fma_f32 v125, v125, s41, -v41
    v_fma_f32 v126, v126, s41, -v41
    v_fma_f32 v127, v127, s41, -v41
    v_exp_f32 v112, v112
    v_exp_f32 v113, v113
    v_exp_f32 v114, v114
    v_exp_f32 v115, v115
    v_exp_f32 v116, v116
    ds_read_b128 a[84:87], v36 offset:8192
    v_mfma_f32_32x32x16_bf16 v[176:191], a[60:63], a[28:31], v[176:191]
    v_exp_f32 v117, v117
    v_exp_f32 v118, v118
    v_exp_f32 v119, v119
    v_exp_f32 v120, v120
    v_exp_f32 v121, v121
    v_exp_f32 v122, v122
    v_exp_f32 v123, v123
    v_exp_f32 v124, v124
    v_exp_f32 v125, v125
    ds_read_b128 a[88:91], v37 offset:8192
    s_waitcnt lgkmcnt(5)
    v_mfma_f32_32x32x16_bf16 v[192:207], a[64:67], a[0:3], 0
    v_exp_f32 v126, v126
    v_exp_f32 v127, v127
    s_nop 0
    v_add_f32 v40, v40, v112
    v_add_f32 v0, v0, v113
    v_add_f32 v40, v40, v114
    v_add_f32 v0, v0, v115
    v_add_f32 v40, v40, v116
    v_add_f32 v0, v0, v117
    ds_read_b128 a[92:95], v38 offset:8192
    v_mfma_f32_32x32x16_bf16 v[192:207], a[68:71], a[4:7], v[192:207]
    v_add_f32 v40, v40, v118
    v_add_f32 v0, v0, v119
    v_add_f32 v40, v40, v120
    v_add_f32 v0, v0, v121
    v_add_f32 v40, v40, v122
    v_add_f32 v0, v0, v123
    v_add_f32 v40, v40, v124
    v_add_f32 v0, v0, v125
    v_add_f32 v40, v40, v126
    v_add_u32 v248, 49152, v23
    v_add_u32 v249, 49152, v24
    v_add_u32 v250, 49152, v25
    v_add_u32 v251, 49152, v26
    v_add_u32 v252, 49152, v27
    v_add_u32 v253, 49152, v28
    v_add_u32 v254, 49152, v29
    v_add_u32 v255, 49152, v30
    ds_read_b128 a[32:35], v248 offset:0
    s_waitcnt lgkmcnt(5)
    v_mfma_f32_32x32x16_bf16 v[192:207], a[72:75], a[8:11], v[192:207]
    v_add_f32 v0, v0, v127
    v_cvt_pk_bf16_f32 v112, v112, v113
    v_cvt_pk_bf16_f32 v113, v114, v115
    v_cvt_pk_bf16_f32 v114, v116, v117
    v_cvt_pk_bf16_f32 v115, v118, v119
    v_cvt_pk_bf16_f32 v116, v120, v121
    v_cvt_pk_bf16_f32 v117, v122, v123
    v_cvt_pk_bf16_f32 v118, v124, v125
    v_cvt_pk_bf16_f32 v119, v126, v127
    ds_read_b128 a[36:39], v249 offset:0
    v_mfma_f32_32x32x16_bf16 v[192:207], a[76:79], a[12:15], v[192:207]
    v_fma_f32 v128, v128, s41, -v41
    v_fma_f32 v129, v129, s41, -v41
    v_fma_f32 v130, v130, s41, -v41
    v_fma_f32 v131, v131, s41, -v41
    v_fma_f32 v132, v132, s41, -v41
    v_fma_f32 v133, v133, s41, -v41
    v_fma_f32 v134, v134, s41, -v41
    v_fma_f32 v135, v135, s41, -v41
    v_fma_f32 v136, v136, s41, -v41
    ds_read_b128 a[40:43], v250 offset:0
    s_waitcnt lgkmcnt(5)
    v_mfma_f32_32x32x16_bf16 v[192:207], a[80:83], a[16:19], v[192:207]
    v_fma_f32 v137, v137, s41, -v41
    v_fma_f32 v138, v138, s41, -v41
    v_fma_f32 v139, v139, s41, -v41
    v_fma_f32 v140, v140, s41, -v41
    v_fma_f32 v141, v141, s41, -v41
    v_fma_f32 v142, v142, s41, -v41
    v_fma_f32 v143, v143, s41, -v41
    v_exp_f32 v128, v128
    v_exp_f32 v129, v129
    ds_read_b128 a[44:47], v251 offset:0
    v_mfma_f32_32x32x16_bf16 v[192:207], a[84:87], a[20:23], v[192:207]
    v_exp_f32 v130, v130
    v_exp_f32 v131, v131
    v_exp_f32 v132, v132
    v_exp_f32 v133, v133
    v_exp_f32 v134, v134
    v_exp_f32 v135, v135
    v_exp_f32 v136, v136
    v_exp_f32 v137, v137
    v_exp_f32 v138, v138
    ds_read_b128 a[48:51], v252 offset:0
    s_waitcnt lgkmcnt(5)
    v_mfma_f32_32x32x16_bf16 v[192:207], a[88:91], a[24:27], v[192:207]
    v_exp_f32 v139, v139
    v_exp_f32 v140, v140
    v_exp_f32 v141, v141
    v_exp_f32 v142, v142
    v_exp_f32 v143, v143
    s_nop 0
    v_add_f32 v40, v40, v128
    v_add_f32 v0, v0, v129
    v_add_f32 v40, v40, v130
    ds_read_b128 a[52:55], v253 offset:0
    v_mfma_f32_32x32x16_bf16 v[192:207], a[92:95], a[28:31], v[192:207]
    v_add_f32 v0, v0, v131
    v_add_f32 v40, v40, v132
    v_add_f32 v0, v0, v133
    v_add_f32 v40, v40, v134
    v_add_f32 v0, v0, v135
    v_add_f32 v40, v40, v136
    v_add_f32 v0, v0, v137
    v_add_f32 v40, v40, v138
    v_add_f32 v0, v0, v139
    ds_read_b128 a[56:59], v254 offset:0
    s_waitcnt lgkmcnt(5)
    v_mfma_f32_32x32x16_bf16 v[208:223], a[32:35], a[0:3], 0
    v_add_f32 v40, v40, v140
    v_add_f32 v0, v0, v141
    v_add_f32 v40, v40, v142
    v_add_f32 v0, v0, v143
    v_cvt_pk_bf16_f32 v128, v128, v129
    v_cvt_pk_bf16_f32 v129, v130, v131
    v_cvt_pk_bf16_f32 v130, v132, v133
    v_cvt_pk_bf16_f32 v131, v134, v135
    v_cvt_pk_bf16_f32 v132, v136, v137
    ds_read_b128 a[60:63], v255 offset:0
    v_mfma_f32_32x32x16_bf16 v[208:223], a[36:39], a[4:7], v[208:223]
    v_cvt_pk_bf16_f32 v133, v138, v139
    v_cvt_pk_bf16_f32 v134, v140, v141
    v_cvt_pk_bf16_f32 v135, v142, v143
    v_fma_f32 v144, v144, s41, -v41
    v_fma_f32 v145, v145, s41, -v41
    v_fma_f32 v146, v146, s41, -v41
    v_fma_f32 v147, v147, s41, -v41
    v_fma_f32 v148, v148, s41, -v41
    v_fma_f32 v149, v149, s41, -v41
    ds_read_b128 a[64:67], v248 offset:8192
    s_waitcnt lgkmcnt(5)
    v_mfma_f32_32x32x16_bf16 v[208:223], a[40:43], a[8:11], v[208:223]
    v_fma_f32 v150, v150, s41, -v41
    v_fma_f32 v151, v151, s41, -v41
    v_fma_f32 v152, v152, s41, -v41
    v_fma_f32 v153, v153, s41, -v41
    v_fma_f32 v154, v154, s41, -v41
    v_fma_f32 v155, v155, s41, -v41
    v_fma_f32 v156, v156, s41, -v41
    v_fma_f32 v157, v157, s41, -v41
    v_fma_f32 v158, v158, s41, -v41
    ds_read_b128 a[68:71], v249 offset:8192
    v_mfma_f32_32x32x16_bf16 v[208:223], a[44:47], a[12:15], v[208:223]
    v_fma_f32 v159, v159, s41, -v41
    v_exp_f32 v144, v144
    v_exp_f32 v145, v145
    v_exp_f32 v146, v146
    v_exp_f32 v147, v147
    v_exp_f32 v148, v148
    v_exp_f32 v149, v149
    v_exp_f32 v150, v150
    v_exp_f32 v151, v151
    ds_read_b128 a[72:75], v250 offset:8192
    s_waitcnt lgkmcnt(5)
    v_mfma_f32_32x32x16_bf16 v[208:223], a[48:51], a[16:19], v[208:223]
    v_exp_f32 v152, v152
    v_exp_f32 v153, v153
    v_exp_f32 v154, v154
    v_exp_f32 v155, v155
    v_exp_f32 v156, v156
    v_exp_f32 v157, v157
    v_exp_f32 v158, v158
    v_exp_f32 v159, v159
    s_nop 0
    ds_read_b128 a[76:79], v251 offset:8192
    v_mfma_f32_32x32x16_bf16 v[208:223], a[52:55], a[20:23], v[208:223]
    v_add_f32 v40, v40, v144
    v_add_f32 v0, v0, v145
    v_add_f32 v40, v40, v146
    v_add_f32 v0, v0, v147
    v_add_f32 v40, v40, v148
    v_add_f32 v0, v0, v149
    v_add_f32 v40, v40, v150
    v_add_f32 v0, v0, v151
    v_add_f32 v40, v40, v152
    ds_read_b128 a[80:83], v252 offset:8192
    s_waitcnt lgkmcnt(5)
    v_mfma_f32_32x32x16_bf16 v[208:223], a[56:59], a[24:27], v[208:223]
    v_add_f32 v0, v0, v153
    v_add_f32 v40, v40, v154
    v_add_f32 v0, v0, v155
    v_add_f32 v40, v40, v156
    v_add_f32 v0, v0, v157
    v_add_f32 v40, v40, v158
    v_add_f32 v0, v0, v159
    v_cvt_pk_bf16_f32 v144, v144, v145
    v_cvt_pk_bf16_f32 v145, v146, v147
    ds_read_b128 a[84:87], v253 offset:8192
    v_mfma_f32_32x32x16_bf16 v[208:223], a[60:63], a[28:31], v[208:223]
    v_cvt_pk_bf16_f32 v146, v148, v149
    v_cvt_pk_bf16_f32 v147, v150, v151
    v_cvt_pk_bf16_f32 v148, v152, v153
    v_cvt_pk_bf16_f32 v149, v154, v155
    v_cvt_pk_bf16_f32 v150, v156, v157
    v_cvt_pk_bf16_f32 v151, v158, v159
    v_fma_f32 v160, v160, s41, -v41
    v_fma_f32 v161, v161, s41, -v41
    v_fma_f32 v162, v162, s41, -v41
    ds_read_b128 a[88:91], v254 offset:8192
    s_waitcnt lgkmcnt(5)
    v_mfma_f32_32x32x16_bf16 v[224:239], a[64:67], a[0:3], 0
    v_fma_f32 v163, v163, s41, -v41
    v_fma_f32 v164, v164, s41, -v41
    v_fma_f32 v165, v165, s41, -v41
    v_fma_f32 v166, v166, s41, -v41
    v_fma_f32 v167, v167, s41, -v41
    v_fma_f32 v168, v168, s41, -v41
    v_fma_f32 v169, v169, s41, -v41
    v_fma_f32 v170, v170, s41, -v41
    v_fma_f32 v171, v171, s41, -v41
    ds_read_b128 a[92:95], v255 offset:8192
    v_mfma_f32_32x32x16_bf16 v[224:239], a[68:71], a[4:7], v[224:239]
    v_fma_f32 v172, v172, s41, -v41
    v_fma_f32 v173, v173, s41, -v41
    v_fma_f32 v174, v174, s41, -v41
    v_fma_f32 v175, v175, s41, -v41
    v_exp_f32 v160, v160
    v_exp_f32 v161, v161
    v_exp_f32 v162, v162
    v_exp_f32 v163, v163
    v_exp_f32 v164, v164
    s_waitcnt lgkmcnt(4)
    v_mfma_f32_32x32x16_bf16 v[224:239], a[72:75], a[8:11], v[224:239]
    v_exp_f32 v165, v165
    v_exp_f32 v166, v166
    v_exp_f32 v167, v167
    v_exp_f32 v168, v168
    v_exp_f32 v169, v169
    v_exp_f32 v170, v170
    v_exp_f32 v171, v171
    v_exp_f32 v172, v172
    v_exp_f32 v173, v173
    v_mfma_f32_32x32x16_bf16 v[224:239], a[76:79], a[12:15], v[224:239]
    v_exp_f32 v174, v174
    v_exp_f32 v175, v175
    s_nop 0
    v_add_f32 v40, v40, v160
    v_add_f32 v0, v0, v161
    v_add_f32 v40, v40, v162
    v_add_f32 v0, v0, v163
    v_add_f32 v40, v40, v164
    v_add_f32 v0, v0, v165
    s_waitcnt lgkmcnt(2)
    v_mfma_f32_32x32x16_bf16 v[224:239], a[80:83], a[16:19], v[224:239]
    v_add_f32 v40, v40, v166
    v_add_f32 v0, v0, v167
    v_add_f32 v40, v40, v168
    v_add_f32 v0, v0, v169
    v_add_f32 v40, v40, v170
    v_add_f32 v0, v0, v171
    v_add_f32 v40, v40, v172
    v_add_f32 v0, v0, v173
    v_add_f32 v40, v40, v174
    v_mfma_f32_32x32x16_bf16 v[224:239], a[84:87], a[20:23], v[224:239]
    v_add_f32 v0, v0, v175
    v_cvt_pk_bf16_f32 v160, v160, v161
    v_cvt_pk_bf16_f32 v161, v162, v163
    v_cvt_pk_bf16_f32 v162, v164, v165
    v_cvt_pk_bf16_f32 v163, v166, v167
    v_cvt_pk_bf16_f32 v164, v168, v169
    v_cvt_pk_bf16_f32 v165, v170, v171
    v_cvt_pk_bf16_f32 v166, v172, v173
    v_cvt_pk_bf16_f32 v167, v174, v175
    s_waitcnt lgkmcnt(0)
    v_mfma_f32_32x32x16_bf16 v[224:239], a[88:91], a[24:27], v[224:239]
    v_mfma_f32_32x32x16_bf16 v[224:239], a[92:95], a[28:31], v[224:239]
    s_waitcnt vmcnt(8) lgkmcnt(0)
    s_barrier
    s_add_u32 m0, s33, 65536
    s_mov_b32 s36, 98304
    buffer_load_dwordx4 v2, s[12:15], s36 offen nt lds
    s_add_u32 m0, s33, 66560
    s_mov_b32 s36, 98304
    buffer_load_dwordx4 v3, s[12:15], s36 offen nt lds
    s_add_u32 m0, s33, 67584
    s_mov_b32 s36, 98304
    buffer_load_dwordx4 v4, s[12:15], s36 offen nt lds
    s_add_u32 m0, s33, 68608
    s_mov_b32 s36, 98304
    buffer_load_dwordx4 v5, s[12:15], s36 offen nt lds
    s_add_u32 m0, s33, 114688
    s_mov_b32 s36, 114688
    buffer_load_dwordx4 v2, s[12:15], s36 offen nt lds
    s_add_u32 m0, s33, 115712
    s_mov_b32 s36, 114688
    buffer_load_dwordx4 v3, s[12:15], s36 offen nt lds
    s_add_u32 m0, s33, 116736
    s_mov_b32 s36, 114688
    buffer_load_dwordx4 v4, s[12:15], s36 offen nt lds
    s_add_u32 m0, s33, 117760
    s_mov_b32 s36, 114688
    buffer_load_dwordx4 v5, s[12:15], s36 offen nt lds
    s_add_u32 m0, s33, 0
    s_mov_b32 s36, 65536
    buffer_load_dwordx4 v6, s[16:19], s36 offen nt lds
    s_add_u32 m0, s33, 1024
    s_mov_b32 s36, 66560
    buffer_load_dwordx4 v6, s[16:19], s36 offen nt lds
    s_add_u32 m0, s33, 2048
    s_mov_b32 s36, 67584
    buffer_load_dwordx4 v6, s[16:19], s36 offen nt lds
    s_add_u32 m0, s33, 3072
    s_mov_b32 s36, 68608
    buffer_load_dwordx4 v6, s[16:19], s36 offen nt lds
    s_add_u32 m0, s33, 49152
    s_mov_b32 s36, 81920
    buffer_load_dwordx4 v6, s[16:19], s36 offen nt lds
    s_add_u32 m0, s33, 50176
    s_mov_b32 s36, 82944
    buffer_load_dwordx4 v6, s[16:19], s36 offen nt lds
    s_add_u32 m0, s33, 51200
    s_mov_b32 s36, 83968
    buffer_load_dwordx4 v6, s[16:19], s36 offen nt lds
    s_add_u32 m0, s33, 52224
    s_mov_b32 s36, 84992
    buffer_load_dwordx4 v6, s[16:19], s36 offen nt lds
    v_add_u32 v31, 131072, v19
    v_add_u32 v32, 131072, v20
    v_add_u32 v33, 131072, v21
    v_add_u32 v34, 131072, v22
    ds_read_b64_tr_b16 a[32:33], v31 offset:0
    ds_read_b64_tr_b16 a[34:35], v31 offset:1024
    ds_read_b64_tr_b16 a[36:37], v32 offset:0
    ds_read_b64_tr_b16 a[38:39], v32 offset:1024
    ds_read_b64_tr_b16 a[40:41], v33 offset:0
    ds_read_b64_tr_b16 a[42:43], v33 offset:1024
    ds_read_b64_tr_b16 a[44:45], v34 offset:0
    ds_read_b64_tr_b16 a[46:47], v34 offset:1024
    ds_read_b64_tr_b16 a[48:49], v31 offset:4096
    ds_read_b64_tr_b16 a[50:51], v31 offset:5120
    ds_read_b64_tr_b16 a[52:53], v32 offset:4096
    ds_read_b64_tr_b16 a[54:55], v32 offset:5120
    ds_read_b64_tr_b16 a[56:57], v33 offset:4096
    ds_read_b64_tr_b16 a[58:59], v33 offset:5120
    s_waitcnt lgkmcnt(10)
    v_mfma_f32_32x32x16_bf16 v[48:63], a[32:35], v[112:115], 0
    v_max3_f32 v43, v176, v177, v178
    v_max3_f32 v43, v43, v179, v180
    v_max3_f32 v43, v43, v181, v182
    v_max3_f32 v43, v43, v183, v184
    v_max3_f32 v43, v43, v185, v186
    v_max3_f32 v43, v43, v187, v188
    v_max3_f32 v43, v43, v189, v190
    v_max_f32 v43, v43, v191
    v_max3_f32 v44, v192, v193, v194
    ds_read_b64_tr_b16 a[60:61], v34 offset:4096
    ds_read_b64_tr_b16 a[62:63], v34 offset:5120
    v_mfma_f32_32x32x16_bf16 v[64:79], a[36:39], v[112:115], 0
    v_max3_f32 v44, v44, v195, v196
    v_max3_f32 v44, v44, v197, v198
    v_max3_f32 v44, v44, v199, v200
    v_max3_f32 v44, v44, v201, v202
    v_max3_f32 v44, v44, v203, v204
    v_max3_f32 v44, v44, v205, v206
    v_max_f32 v44, v44, v207
    v_max3_f32 v45, v208, v209, v210
    v_max3_f32 v45, v45, v211, v212
    ds_read_b64_tr_b16 a[64:65], v31 offset:8192
    ds_read_b64_tr_b16 a[66:67], v31 offset:9216
    s_waitcnt lgkmcnt(10)
    v_mfma_f32_32x32x16_bf16 v[80:95], a[40:43], v[112:115], 0
    v_max3_f32 v45, v45, v213, v214
    v_max3_f32 v45, v45, v215, v216
    v_max3_f32 v45, v45, v217, v218
    v_max3_f32 v45, v45, v219, v220
    v_max3_f32 v45, v45, v221, v222
    v_max_f32 v45, v45, v223
    v_max3_f32 v46, v224, v225, v226
    v_max3_f32 v46, v46, v227, v228
    v_max3_f32 v46, v46, v229, v230
    ds_read_b64_tr_b16 a[68:69], v32 offset:8192
    ds_read_b64_tr_b16 a[70:71], v32 offset:9216
    v_mfma_f32_32x32x16_bf16 v[96:111], a[44:47], v[112:115], 0
    v_max3_f32 v46, v46, v231, v232
    v_max3_f32 v46, v46, v233, v234
    v_max3_f32 v46, v46, v235, v236
    v_max3_f32 v46, v46, v237, v238
    v_max_f32 v46, v46, v239
    v_max3_f32 v43, v43, v44, v45
    v_max_f32 v43, v43, v46
    v_mov_b32 v44, v43
    s_nop 1
    ds_read_b64_tr_b16 a[72:73], v33 offset:8192
    ds_read_b64_tr_b16 a[74:75], v33 offset:9216
    s_waitcnt lgkmcnt(10)
    v_mfma_f32_32x32x16_bf16 v[48:63], a[48:51], v[116:119], v[48:63]
    v_permlane32_swap_b32 v43, v44
    v_max_f32 v43, v43, v44
    v_max_f32 v43, v43, v39
    v_sub_f32 v44, v39, v43
    v_mul_f32 v44, s41, v44
    v_exp_f32 v42, v44
    v_mov_b32 v39, v43
    s_nop 0
    v_mul_f32 v40, v40, v42
    ds_read_b64_tr_b16 a[76:77], v34 offset:8192
    ds_read_b64_tr_b16 a[78:79], v34 offset:9216
    v_mfma_f32_32x32x16_bf16 v[64:79], a[52:55], v[116:119], v[64:79]
    v_mul_f32 v0, v0, v42
    v_mul_f32 v41, s41, v39
    v_fma_f32 v176, v176, s41, -v41
    v_fma_f32 v177, v177, s41, -v41
    v_fma_f32 v178, v178, s41, -v41
    v_fma_f32 v179, v179, s41, -v41
    v_fma_f32 v180, v180, s41, -v41
    v_fma_f32 v181, v181, s41, -v41
    v_fma_f32 v182, v182, s41, -v41
    ds_read_b64_tr_b16 a[80:81], v31 offset:12288
    ds_read_b64_tr_b16 a[82:83], v31 offset:13312
    s_waitcnt lgkmcnt(10)
    v_mfma_f32_32x32x16_bf16 v[80:95], a[56:59], v[116:119], v[80:95]
    v_fma_f32 v183, v183, s41, -v41
    v_fma_f32 v184, v184, s41, -v41
    v_fma_f32 v185, v185, s41, -v41
    v_fma_f32 v186, v186, s41, -v41
    v_fma_f32 v187, v187, s41, -v41
    v_fma_f32 v188, v188, s41, -v41
    v_fma_f32 v189, v189, s41, -v41
    v_fma_f32 v190, v190, s41, -v41
    v_fma_f32 v191, v191, s41, -v41
    ds_read_b64_tr_b16 a[84:85], v32 offset:12288
    ds_read_b64_tr_b16 a[86:87], v32 offset:13312
    v_mfma_f32_32x32x16_bf16 v[96:111], a[60:63], v[116:119], v[96:111]
    v_exp_f32 v176, v176
    v_exp_f32 v177, v177
    v_exp_f32 v178, v178
    v_exp_f32 v179, v179
    v_exp_f32 v180, v180
    v_exp_f32 v181, v181
    v_exp_f32 v182, v182
    v_exp_f32 v183, v183
    v_exp_f32 v184, v184
    ds_read_b64_tr_b16 a[88:89], v33 offset:12288
    ds_read_b64_tr_b16 a[90:91], v33 offset:13312
    s_waitcnt lgkmcnt(10)
    v_mfma_f32_32x32x16_bf16 v[48:63], a[64:67], v[128:131], v[48:63]
    v_exp_f32 v185, v185
    v_exp_f32 v186, v186
    v_exp_f32 v187, v187
    v_exp_f32 v188, v188
    v_exp_f32 v189, v189
    v_exp_f32 v190, v190
    v_exp_f32 v191, v191
    s_nop 0
    v_add_f32 v40, v40, v176
    ds_read_b64_tr_b16 a[92:93], v34 offset:12288
    ds_read_b64_tr_b16 a[94:95], v34 offset:13312
    v_mfma_f32_32x32x16_bf16 v[64:79], a[68:71], v[128:131], v[64:79]
    v_add_f32 v0, v0, v177
    v_add_f32 v40, v40, v178
    v_add_f32 v0, v0, v179
    v_add_f32 v40, v40, v180
    v_add_f32 v0, v0, v181
    v_add_f32 v40, v40, v182
    v_add_f32 v0, v0, v183
    v_add_f32 v40, v40, v184
    v_add_f32 v0, v0, v185
    v_add_u32 v248, 32768, v19
    v_add_u32 v249, 32768, v20
    v_add_u32 v250, 32768, v21
    v_add_u32 v251, 32768, v22
    ds_read_b64_tr_b16 a[32:33], v248 offset:0
    ds_read_b64_tr_b16 a[34:35], v248 offset:1024
    s_waitcnt lgkmcnt(10)
    v_mfma_f32_32x32x16_bf16 v[80:95], a[72:75], v[128:131], v[80:95]
    v_add_f32 v40, v40, v186
    v_add_f32 v0, v0, v187
    v_add_f32 v40, v40, v188
    v_add_f32 v0, v0, v189
    v_add_f32 v40, v40, v190
    v_add_f32 v0, v0, v191
    v_cvt_pk_bf16_f32 v176, v176, v177
    v_cvt_pk_bf16_f32 v177, v178, v179
    v_cvt_pk_bf16_f32 v178, v180, v181
    ds_read_b64_tr_b16 a[36:37], v249 offset:0
    ds_read_b64_tr_b16 a[38:39], v249 offset:1024
    v_mfma_f32_32x32x16_bf16 v[96:111], a[76:79], v[128:131], v[96:111]
    v_cvt_pk_bf16_f32 v179, v182, v183
    v_cvt_pk_bf16_f32 v180, v184, v185
    v_cvt_pk_bf16_f32 v181, v186, v187
    v_cvt_pk_bf16_f32 v182, v188, v189
    v_cvt_pk_bf16_f32 v183, v190, v191
    v_fma_f32 v192, v192, s41, -v41
    v_fma_f32 v193, v193, s41, -v41
    v_fma_f32 v194, v194, s41, -v41
    v_fma_f32 v195, v195, s41, -v41
    ds_read_b64_tr_b16 a[40:41], v250 offset:0
    ds_read_b64_tr_b16 a[42:43], v250 offset:1024
    s_waitcnt lgkmcnt(10)
    v_mfma_f32_32x32x16_bf16 v[48:63], a[80:83], v[132:135], v[48:63]
    v_fma_f32 v196, v196, s41, -v41
    v_fma_f32 v197, v197, s41, -v41
    v_fma_f32 v198, v198, s41, -v41
    v_fma_f32 v199, v199, s41, -v41
    v_fma_f32 v200, v200, s41, -v41
    v_fma_f32 v201, v201, s41, -v41
    v_fma_f32 v202, v202, s41, -v41
    v_fma_f32 v203, v203, s41, -v41
    v_fma_f32 v204, v204, s41, -v41
    ds_read_b64_tr_b16 a[44:45], v251 offset:0
    ds_read_b64_tr_b16 a[46:47], v251 offset:1024
    v_mfma_f32_32x32x16_bf16 v[64:79], a[84:87], v[132:135], v[64:79]
    v_fma_f32 v205, v205, s41, -v41
    v_fma_f32 v206, v206, s41, -v41
    v_fma_f32 v207, v207, s41, -v41
    v_exp_f32 v192, v192
    v_exp_f32 v193, v193
    v_exp_f32 v194, v194
    v_exp_f32 v195, v195
    v_exp_f32 v196, v196
    v_exp_f32 v197, v197
    ds_read_b64_tr_b16 a[48:49], v248 offset:4096
    ds_read_b64_tr_b16 a[50:51], v248 offset:5120
    s_waitcnt lgkmcnt(10)
    v_mfma_f32_32x32x16_bf16 v[80:95], a[88:91], v[132:135], v[80:95]
    v_exp_f32 v198, v198
    v_exp_f32 v199, v199
    v_exp_f32 v200, v200
    v_exp_f32 v201, v201
    v_exp_f32 v202, v202
    v_exp_f32 v203, v203
    v_exp_f32 v204, v204
    v_exp_f32 v205, v205
    v_exp_f32 v206, v206
    ds_read_b64_tr_b16 a[52:53], v249 offset:4096
    ds_read_b64_tr_b16 a[54:55], v249 offset:5120
    v_mfma_f32_32x32x16_bf16 v[96:111], a[92:95], v[132:135], v[96:111]
    v_exp_f32 v207, v207
    s_nop 0
    v_add_f32 v40, v40, v192
    v_add_f32 v0, v0, v193
    v_add_f32 v40, v40, v194
    v_add_f32 v0, v0, v195
    v_add_f32 v40, v40, v196
    v_add_f32 v0, v0, v197
    v_add_f32 v40, v40, v198
    ds_read_b64_tr_b16 a[56:57], v250 offset:4096
    ds_read_b64_tr_b16 a[58:59], v250 offset:5120
    s_waitcnt lgkmcnt(10)
    v_mfma_f32_32x32x16_bf16 v[48:63], a[32:35], v[144:147], v[48:63]
    v_add_f32 v0, v0, v199
    v_add_f32 v40, v40, v200
    v_add_f32 v0, v0, v201
    v_add_f32 v40, v40, v202
    v_add_f32 v0, v0, v203
    v_add_f32 v40, v40, v204
    v_add_f32 v0, v0, v205
    v_add_f32 v40, v40, v206
    v_add_f32 v0, v0, v207
    ds_read_b64_tr_b16 a[60:61], v251 offset:4096
    ds_read_b64_tr_b16 a[62:63], v251 offset:5120
    v_mfma_f32_32x32x16_bf16 v[64:79], a[36:39], v[144:147], v[64:79]
    v_cvt_pk_bf16_f32 v192, v192, v193
    v_cvt_pk_bf16_f32 v193, v194, v195
    v_cvt_pk_bf16_f32 v194, v196, v197
    v_cvt_pk_bf16_f32 v195, v198, v199
    v_cvt_pk_bf16_f32 v196, v200, v201
    v_cvt_pk_bf16_f32 v197, v202, v203
    v_cvt_pk_bf16_f32 v198, v204, v205
    v_cvt_pk_bf16_f32 v199, v206, v207
    v_fma_f32 v208, v208, s41, -v41
    ds_read_b64_tr_b16 a[64:65], v248 offset:8192
    ds_read_b64_tr_b16 a[66:67], v248 offset:9216
    s_waitcnt lgkmcnt(10)
    v_mfma_f32_32x32x16_bf16 v[80:95], a[40:43], v[144:147], v[80:95]
    v_fma_f32 v209, v209, s41, -v41
    v_fma_f32 v210, v210, s41, -v41
    v_fma_f32 v211, v211, s41, -v41
    v_fma_f32 v212, v212, s41, -v41
    v_fma_f32 v213, v213, s41, -v41
    v_fma_f32 v214, v214, s41, -v41
    v_fma_f32 v215, v215, s41, -v41
    v_fma_f32 v216, v216, s41, -v41
    v_fma_f32 v217, v217, s41, -v41
    ds_read_b64_tr_b16 a[68:69], v249 offset:8192
    ds_read_b64_tr_b16 a[70:71], v249 offset:9216
    v_mfma_f32_32x32x16_bf16 v[96:111], a[44:47], v[144:147], v[96:111]
    v_fma_f32 v218, v218, s41, -v41
    v_fma_f32 v219, v219, s41, -v41
    v_fma_f32 v220, v220, s41, -v41
    v_fma_f32 v221, v221, s41, -v41
    v_fma_f32 v222, v222, s41, -v41
    v_fma_f32 v223, v223, s41, -v41
    v_exp_f32 v208, v208
    v_exp_f32 v209, v209
    v_exp_f32 v210, v210
    ds_read_b64_tr_b16 a[72:73], v250 offset:8192
    ds_read_b64_tr_b16 a[74:75], v250 offset:9216
    s_waitcnt lgkmcnt(10)
    v_mfma_f32_32x32x16_bf16 v[48:63], a[48:51], v[148:151], v[48:63]
    v_exp_f32 v211, v211
    v_exp_f32 v212, v212
    v_exp_f32 v213, v213
    v_exp_f32 v214, v214
    v_exp_f32 v215, v215
    v_exp_f32 v216, v216
    v_exp_f32 v217, v217
    v_exp_f32 v218, v218
    v_exp_f32 v219, v219
    ds_read_b64_tr_b16 a[76:77], v251 offset:8192
    ds_read_b64_tr_b16 a[78:79], v251 offset:9216
    v_mfma_f32_32x32x16_bf16 v[64:79], a[52:55], v[148:151], v[64:79]
    v_exp_f32 v220, v220
    v_exp_f32 v221, v221
    v_exp_f32 v222, v222
    v_exp_f32 v223, v223
    s_nop 0
    v_add_f32 v40, v40, v208
    v_add_f32 v0, v0, v209
    v_add_f32 v40, v40, v210
    v_add_f32 v0, v0, v211
    ds_read_b64_tr_b16 a[80:81], v248 offset:12288
    ds_read_b64_tr_b16 a[82:83], v248 offset:13312
    s_waitcnt lgkmcnt(10)
    v_mfma_f32_32x32x16_bf16 v[80:95], a[56:59], v[148:151], v[80:95]
    v_add_f32 v40, v40, v212
    v_add_f32 v0, v0, v213
    v_add_f32 v40, v40, v214
    v_add_f32 v0, v0, v215
    v_add_f32 v40, v40, v216
    v_add_f32 v0, v0, v217
    v_add_f32 v40, v40, v218
    v_add_f32 v0, v0, v219
    v_add_f32 v40, v40, v220
    ds_read_b64_tr_b16 a[84:85], v249 offset:12288
    ds_read_b64_tr_b16 a[86:87], v249 offset:13312
    v_mfma_f32_32x32x16_bf16 v[96:111], a[60:63], v[148:151], v[96:111]
    v_add_f32 v0, v0, v221
    v_add_f32 v40, v40, v222
    v_add_f32 v0, v0, v223
    v_cvt_pk_bf16_f32 v208, v208, v209
    v_cvt_pk_bf16_f32 v209, v210, v211
    v_cvt_pk_bf16_f32 v210, v212, v213
    v_cvt_pk_bf16_f32 v211, v214, v215
    v_cvt_pk_bf16_f32 v212, v216, v217
    v_cvt_pk_bf16_f32 v213, v218, v219
    ds_read_b64_tr_b16 a[88:89], v250 offset:12288
    ds_read_b64_tr_b16 a[90:91], v250 offset:13312
    s_waitcnt lgkmcnt(10)
    v_mfma_f32_32x32x16_bf16 v[48:63], a[64:67], v[160:163], v[48:63]
    v_cvt_pk_bf16_f32 v214, v220, v221
    v_cvt_pk_bf16_f32 v215, v222, v223
    v_fma_f32 v224, v224, s41, -v41
    v_fma_f32 v225, v225, s41, -v41
    v_fma_f32 v226, v226, s41, -v41
    v_fma_f32 v227, v227, s41, -v41
    v_fma_f32 v228, v228, s41, -v41
    v_fma_f32 v229, v229, s41, -v41
    v_fma_f32 v230, v230, s41, -v41
    ds_read_b64_tr_b16 a[92:93], v251 offset:12288
    ds_read_b64_tr_b16 a[94:95], v251 offset:13312
    v_mfma_f32_32x32x16_bf16 v[64:79], a[68:71], v[160:163], v[64:79]
    v_fma_f32 v231, v231, s41, -v41
    v_fma_f32 v232, v232, s41, -v41
    v_fma_f32 v233, v233, s41, -v41
    v_fma_f32 v234, v234, s41, -v41
    v_fma_f32 v235, v235, s41, -v41
    v_fma_f32 v236, v236, s41, -v41
    v_fma_f32 v237, v237, s41, -v41
    v_fma_f32 v238, v238, s41, -v41
    v_fma_f32 v239, v239, s41, -v41
    v_add_u32 v31, 147456, v23
    v_add_u32 v32, 147456, v24
    v_add_u32 v33, 147456, v25
    v_add_u32 v34, 147456, v26
    v_add_u32 v35, 147456, v27
    v_add_u32 v36, 147456, v28
    v_add_u32 v37, 147456, v29
    v_add_u32 v38, 147456, v30
    ds_read_b128 a[32:35], v31 offset:0
    s_waitcnt lgkmcnt(9)
    v_mfma_f32_32x32x16_bf16 v[80:95], a[72:75], v[160:163], v[80:95]
    v_exp_f32 v224, v224
    v_exp_f32 v225, v225
    v_exp_f32 v226, v226
    v_exp_f32 v227, v227
    v_exp_f32 v228, v228
    v_exp_f32 v229, v229
    v_exp_f32 v230, v230
    v_exp_f32 v231, v231
    v_exp_f32 v232, v232
    ds_read_b128 a[36:39], v32 offset:0
    v_mfma_f32_32x32x16_bf16 v[96:111], a[76:79], v[160:163], v[96:111]
    v_exp_f32 v233, v233
    v_exp_f32 v234, v234
    v_exp_f32 v235, v235
    v_exp_f32 v236, v236
    v_exp_f32 v237, v237
    v_exp_f32 v238, v238
    v_exp_f32 v239, v239
    s_nop 0
    v_add_f32 v40, v40, v224
    ds_read_b128 a[40:43], v33 offset:0
    s_waitcnt lgkmcnt(7)
    v_mfma_f32_32x32x16_bf16 v[48:63], a[80:83], v[164:167], v[48:63]
    v_add_f32 v0, v0, v225
    v_add_f32 v40, v40, v226
    v_add_f32 v0, v0, v227
    v_add_f32 v40, v40, v228
    v_add_f32 v0, v0, v229
    v_add_f32 v40, v40, v230
    v_add_f32 v0, v0, v231
    v_add_f32 v40, v40, v232
    v_add_f32 v0, v0, v233
    ds_read_b128 a[44:47], v34 offset:0
    v_mfma_f32_32x32x16_bf16 v[64:79], a[84:87], v[164:167], v[64:79]
    v_add_f32 v40, v40, v234
    v_add_f32 v0, v0, v235
    v_add_f32 v40, v40, v236
    v_add_f32 v0, v0, v237
    v_add_f32 v40, v40, v238
    v_add_f32 v0, v0, v239
    v_cvt_pk_bf16_f32 v224, v224, v225
    v_cvt_pk_bf16_f32 v225, v226, v227
    v_cvt_pk_bf16_f32 v226, v228, v229
    ds_read_b128 a[48:51], v35 offset:0
    s_waitcnt lgkmcnt(5)
    v_mfma_f32_32x32x16_bf16 v[80:95], a[88:91], v[164:167], v[80:95]
    v_cvt_pk_bf16_f32 v227, v230, v231
    v_cvt_pk_bf16_f32 v228, v232, v233
    v_cvt_pk_bf16_f32 v229, v234, v235
    v_cvt_pk_bf16_f32 v230, v236, v237
    v_cvt_pk_bf16_f32 v231, v238, v239
    ds_read_b128 a[52:55], v36 offset:0
    v_mfma_f32_32x32x16_bf16 v[96:111], a[92:95], v[164:167], v[96:111]
    ds_read_b128 a[56:59], v37 offset:0
    s_waitcnt lgkmcnt(5)
    v_mfma_f32_32x32x16_bf16 v[112:127], a[32:35], a[0:3], 0
    s_nop 7
    s_nop 7
    v_mul_f32 v48, v48, v42
    ds_read_b128 a[60:63], v38 offset:0
    v_mfma_f32_32x32x16_bf16 v[112:127], a[36:39], a[4:7], v[112:127]
    v_mul_f32 v49, v49, v42
    v_mul_f32 v50, v50, v42
    v_mul_f32 v51, v51, v42
    ds_read_b128 a[64:67], v31 offset:8192
    s_waitcnt lgkmcnt(5)
    v_mfma_f32_32x32x16_bf16 v[112:127], a[40:43], a[8:11], v[112:127]
    v_mul_f32 v52, v52, v42
    v_mul_f32 v53, v53, v42
    v_mul_f32 v54, v54, v42
    ds_read_b128 a[68:71], v32 offset:8192
    v_mfma_f32_32x32x16_bf16 v[112:127], a[44:47], a[12:15], v[112:127]
    v_mul_f32 v55, v55, v42
    v_mul_f32 v56, v56, v42
    v_mul_f32 v57, v57, v42
    ds_read_b128 a[72:75], v33 offset:8192
    s_waitcnt lgkmcnt(5)
    v_mfma_f32_32x32x16_bf16 v[112:127], a[48:51], a[16:19], v[112:127]
    v_mul_f32 v58, v58, v42
    v_mul_f32 v59, v59, v42
    v_mul_f32 v60, v60, v42
    ds_read_b128 a[76:79], v34 offset:8192
    v_mfma_f32_32x32x16_bf16 v[112:127], a[52:55], a[20:23], v[112:127]
    v_mul_f32 v61, v61, v42
    v_mul_f32 v62, v62, v42
    v_mul_f32 v63, v63, v42
    ds_read_b128 a[80:83], v35 offset:8192
    s_waitcnt lgkmcnt(5)
    v_mfma_f32_32x32x16_bf16 v[112:127], a[56:59], a[24:27], v[112:127]
    v_mul_f32 v64, v64, v42
    v_mul_f32 v65, v65, v42
    v_mul_f32 v66, v66, v42
    ds_read_b128 a[84:87], v36 offset:8192
    v_mfma_f32_32x32x16_bf16 v[112:127], a[60:63], a[28:31], v[112:127]
    v_mul_f32 v67, v67, v42
    v_mul_f32 v68, v68, v42
    v_mul_f32 v69, v69, v42
    ds_read_b128 a[88:91], v37 offset:8192
    s_waitcnt lgkmcnt(5)
    v_mfma_f32_32x32x16_bf16 v[128:143], a[64:67], a[0:3], 0
    v_mul_f32 v70, v70, v42
    v_mul_f32 v71, v71, v42
    v_mul_f32 v72, v72, v42
    ds_read_b128 a[92:95], v38 offset:8192
    v_mfma_f32_32x32x16_bf16 v[128:143], a[68:71], a[4:7], v[128:143]
    v_mul_f32 v73, v73, v42
    v_mul_f32 v74, v74, v42
    v_mul_f32 v75, v75, v42
    v_add_u32 v248, 16384, v23
    v_add_u32 v249, 16384, v24
    v_add_u32 v250, 16384, v25
    v_add_u32 v251, 16384, v26
    v_add_u32 v252, 16384, v27
    v_add_u32 v253, 16384, v28
    v_add_u32 v254, 16384, v29
    v_add_u32 v255, 16384, v30
    ds_read_b128 a[32:35], v248 offset:0
    s_waitcnt lgkmcnt(5)
    v_mfma_f32_32x32x16_bf16 v[128:143], a[72:75], a[8:11], v[128:143]
    v_mul_f32 v76, v76, v42
    v_mul_f32 v77, v77, v42
    v_mul_f32 v78, v78, v42
    ds_read_b128 a[36:39], v249 offset:0
    v_mfma_f32_32x32x16_bf16 v[128:143], a[76:79], a[12:15], v[128:143]
    v_mul_f32 v79, v79, v42
    v_mul_f32 v80, v80, v42
    v_mul_f32 v81, v81, v42
    ds_read_b128 a[40:43], v250 offset:0
    s_waitcnt lgkmcnt(5)
    v_mfma_f32_32x32x16_bf16 v[128:143], a[80:83], a[16:19], v[128:143]
    v_mul_f32 v82, v82, v42
    v_mul_f32 v83, v83, v42
    v_mul_f32 v84, v84, v42
    ds_read_b128 a[44:47], v251 offset:0
    v_mfma_f32_32x32x16_bf16 v[128:143], a[84:87], a[20:23], v[128:143]
    v_mul_f32 v85, v85, v42
    v_mul_f32 v86, v86, v42
    v_mul_f32 v87, v87, v42
    ds_read_b128 a[48:51], v252 offset:0
    s_waitcnt lgkmcnt(5)
    v_mfma_f32_32x32x16_bf16 v[128:143], a[88:91], a[24:27], v[128:143]
    v_mul_f32 v88, v88, v42
    v_mul_f32 v89, v89, v42
    v_mul_f32 v90, v90, v42
    ds_read_b128 a[52:55], v253 offset:0
    v_mfma_f32_32x32x16_bf16 v[128:143], a[92:95], a[28:31], v[128:143]
    v_mul_f32 v91, v91, v42
    v_mul_f32 v92, v92, v42
    v_mul_f32 v93, v93, v42
    ds_read_b128 a[56:59], v254 offset:0
    s_waitcnt lgkmcnt(5)
    v_mfma_f32_32x32x16_bf16 v[144:159], a[32:35], a[0:3], 0
    v_mul_f32 v94, v94, v42
    v_mul_f32 v95, v95, v42
    v_mul_f32 v96, v96, v42
    ds_read_b128 a[60:63], v255 offset:0
    v_mfma_f32_32x32x16_bf16 v[144:159], a[36:39], a[4:7], v[144:159]
    v_mul_f32 v97, v97, v42
    v_mul_f32 v98, v98, v42
    v_mul_f32 v99, v99, v42
    ds_read_b128 a[64:67], v248 offset:8192
    s_waitcnt lgkmcnt(5)
    v_mfma_f32_32x32x16_bf16 v[144:159], a[40:43], a[8:11], v[144:159]
    v_mul_f32 v100, v100, v42
    v_mul_f32 v101, v101, v42
    v_mul_f32 v102, v102, v42
    ds_read_b128 a[68:71], v249 offset:8192
    v_mfma_f32_32x32x16_bf16 v[144:159], a[44:47], a[12:15], v[144:159]
    v_mul_f32 v103, v103, v42
    v_mul_f32 v104, v104, v42
    v_mul_f32 v105, v105, v42
    ds_read_b128 a[72:75], v250 offset:8192
    s_waitcnt lgkmcnt(5)
    v_mfma_f32_32x32x16_bf16 v[144:159], a[48:51], a[16:19], v[144:159]
    v_mul_f32 v106, v106, v42
    v_mul_f32 v107, v107, v42
    v_mul_f32 v108, v108, v42
    ds_read_b128 a[76:79], v251 offset:8192
    v_mfma_f32_32x32x16_bf16 v[144:159], a[52:55], a[20:23], v[144:159]
    v_mul_f32 v109, v109, v42
    v_mul_f32 v110, v110, v42
    v_mul_f32 v111, v111, v42
    ds_read_b128 a[80:83], v252 offset:8192
    s_waitcnt lgkmcnt(5)
    v_mfma_f32_32x32x16_bf16 v[144:159], a[56:59], a[24:27], v[144:159]
    ds_read_b128 a[84:87], v253 offset:8192
    v_mfma_f32_32x32x16_bf16 v[144:159], a[60:63], a[28:31], v[144:159]
    ds_read_b128 a[88:91], v254 offset:8192
    s_waitcnt lgkmcnt(5)
    v_mfma_f32_32x32x16_bf16 v[160:175], a[64:67], a[0:3], 0
    ds_read_b128 a[92:95], v255 offset:8192
    v_mfma_f32_32x32x16_bf16 v[160:175], a[68:71], a[4:7], v[160:175]
    s_waitcnt lgkmcnt(4)
    v_mfma_f32_32x32x16_bf16 v[160:175], a[72:75], a[8:11], v[160:175]
    v_mfma_f32_32x32x16_bf16 v[160:175], a[76:79], a[12:15], v[160:175]
    s_waitcnt lgkmcnt(2)
    v_mfma_f32_32x32x16_bf16 v[160:175], a[80:83], a[16:19], v[160:175]
    v_mfma_f32_32x32x16_bf16 v[160:175], a[84:87], a[20:23], v[160:175]
    s_waitcnt lgkmcnt(0)
    v_mfma_f32_32x32x16_bf16 v[160:175], a[88:91], a[24:27], v[160:175]
    v_mfma_f32_32x32x16_bf16 v[160:175], a[92:95], a[28:31], v[160:175]
    s_waitcnt vmcnt(8) lgkmcnt(0)
    s_barrier
    s_add_u32 m0, s33, 131072
    s_mov_b32 s36, 98304
    buffer_load_dwordx4 v6, s[16:19], s36 offen nt lds
    s_add_u32 m0, s33, 132096
    s_mov_b32 s36, 99328
    buffer_load_dwordx4 v6, s[16:19], s36 offen nt lds
    s_add_u32 m0, s33, 133120
    s_mov_b32 s36, 100352
    buffer_load_dwordx4 v6, s[16:19], s36 offen nt lds
    s_add_u32 m0, s33, 134144
    s_mov_b32 s36, 101376
    buffer_load_dwordx4 v6, s[16:19], s36 offen nt lds
    s_add_u32 m0, s33, 32768
    s_mov_b32 s36, 114688
    buffer_load_dwordx4 v6, s[16:19], s36 offen nt lds
    s_add_u32 m0, s33, 33792
    s_mov_b32 s36, 115712
    buffer_load_dwordx4 v6, s[16:19], s36 offen nt lds
    s_add_u32 m0, s33, 34816
    s_mov_b32 s36, 116736
    buffer_load_dwordx4 v6, s[16:19], s36 offen nt lds
    s_add_u32 m0, s33, 35840
    s_mov_b32 s36, 117760
    buffer_load_dwordx4 v6, s[16:19], s36 offen nt lds
    v_add_u32 v31, 81920, v19
    v_add_u32 v32, 81920, v20
    v_add_u32 v33, 81920, v21
    v_add_u32 v34, 81920, v22
    ds_read_b64_tr_b16 a[32:33], v31 offset:0
    ds_read_b64_tr_b16 a[34:35], v31 offset:1024
    ds_read_b64_tr_b16 a[36:37], v32 offset:0
    ds_read_b64_tr_b16 a[38:39], v32 offset:1024
    ds_read_b64_tr_b16 a[40:41], v33 offset:0
    ds_read_b64_tr_b16 a[42:43], v33 offset:1024
    ds_read_b64_tr_b16 a[44:45], v34 offset:0
    ds_read_b64_tr_b16 a[46:47], v34 offset:1024
    ds_read_b64_tr_b16 a[48:49], v31 offset:4096
    ds_read_b64_tr_b16 a[50:51], v31 offset:5120
    ds_read_b64_tr_b16 a[52:53], v32 offset:4096
    ds_read_b64_tr_b16 a[54:55], v32 offset:5120
    ds_read_b64_tr_b16 a[56:57], v33 offset:4096
    ds_read_b64_tr_b16 a[58:59], v33 offset:5120
    s_waitcnt lgkmcnt(10)
    v_mfma_f32_32x32x16_bf16 v[48:63], a[32:35], v[176:179], v[48:63]
    v_max3_f32 v43, v112, v113, v114
    v_max3_f32 v43, v43, v115, v116
    v_max3_f32 v43, v43, v117, v118
    v_max3_f32 v43, v43, v119, v120
    v_max3_f32 v43, v43, v121, v122
    v_max3_f32 v43, v43, v123, v124
    v_max3_f32 v43, v43, v125, v126
    v_max_f32 v43, v43, v127
    v_max3_f32 v44, v128, v129, v130
    ds_read_b64_tr_b16 a[60:61], v34 offset:4096
    ds_read_b64_tr_b16 a[62:63], v34 offset:5120
    v_mfma_f32_32x32x16_bf16 v[64:79], a[36:39], v[176:179], v[64:79]
    v_max3_f32 v44, v44, v131, v132
    v_max3_f32 v44, v44, v133, v134
    v_max3_f32 v44, v44, v135, v136
    v_max3_f32 v44, v44, v137, v138
    v_max3_f32 v44, v44, v139, v140
    v_max3_f32 v44, v44, v141, v142
    v_max_f32 v44, v44, v143
    v_max3_f32 v45, v144, v145, v146
    v_max3_f32 v45, v45, v147, v148
    ds_read_b64_tr_b16 a[64:65], v31 offset:8192
    ds_read_b64_tr_b16 a[66:67], v31 offset:9216
    s_waitcnt lgkmcnt(10)
    v_mfma_f32_32x32x16_bf16 v[80:95], a[40:43], v[176:179], v[80:95]
    v_max3_f32 v45, v45, v149, v150
    v_max3_f32 v45, v45, v151, v152
    v_max3_f32 v45, v45, v153, v154
    v_max3_f32 v45, v45, v155, v156
    v_max3_f32 v45, v45, v157, v158
    v_max_f32 v45, v45, v159
    v_max3_f32 v46, v160, v161, v162
    v_max3_f32 v46, v46, v163, v164
    v_max3_f32 v46, v46, v165, v166
    ds_read_b64_tr_b16 a[68:69], v32 offset:8192
    ds_read_b64_tr_b16 a[70:71], v32 offset:9216
    v_mfma_f32_32x32x16_bf16 v[96:111], a[44:47], v[176:179], v[96:111]
    v_max3_f32 v46, v46, v167, v168
    v_max3_f32 v46, v46, v169, v170
    v_max3_f32 v46, v46, v171, v172
    v_max3_f32 v46, v46, v173, v174
    v_max_f32 v46, v46, v175
    v_max3_f32 v43, v43, v44, v45
    v_max_f32 v43, v43, v46
    v_mov_b32 v44, v43
    s_nop 1
    ds_read_b64_tr_b16 a[72:73], v33 offset:8192
    ds_read_b64_tr_b16 a[74:75], v33 offset:9216
    s_waitcnt lgkmcnt(10)
    v_mfma_f32_32x32x16_bf16 v[48:63], a[48:51], v[180:183], v[48:63]
    v_permlane32_swap_b32 v43, v44
    v_max_f32 v43, v43, v44
    v_max_f32 v43, v43, v39
    v_sub_f32 v44, v39, v43
    v_mul_f32 v44, s41, v44
    v_exp_f32 v42, v44
    v_mov_b32 v39, v43
    s_nop 0
    v_mul_f32 v40, v40, v42
    ds_read_b64_tr_b16 a[76:77], v34 offset:8192
    ds_read_b64_tr_b16 a[78:79], v34 offset:9216
    v_mfma_f32_32x32x16_bf16 v[64:79], a[52:55], v[180:183], v[64:79]
    v_mul_f32 v0, v0, v42
    v_mul_f32 v41, s41, v39
    v_fma_f32 v112, v112, s41, -v41
    v_fma_f32 v113, v113, s41, -v41
    v_fma_f32 v114, v114, s41, -v41
    v_fma_f32 v115, v115, s41, -v41
    v_fma_f32 v116, v116, s41, -v41
    v_fma_f32 v117, v117, s41, -v41
    v_fma_f32 v118, v118, s41, -v41
    ds_read_b64_tr_b16 a[80:81], v31 offset:12288
    ds_read_b64_tr_b16 a[82:83], v31 offset:13312
    s_waitcnt lgkmcnt(10)
    v_mfma_f32_32x32x16_bf16 v[80:95], a[56:59], v[180:183], v[80:95]
    v_fma_f32 v119, v119, s41, -v41
    v_fma_f32 v120, v120, s41, -v41
    v_fma_f32 v121, v121, s41, -v41
    v_fma_f32 v122, v122, s41, -v41
    v_fma_f32 v123, v123, s41, -v41
    v_fma_f32 v124, v124, s41, -v41
    v_fma_f32 v125, v125, s41, -v41
    v_fma_f32 v126, v126, s41, -v41
    v_fma_f32 v127, v127, s41, -v41
    ds_read_b64_tr_b16 a[84:85], v32 offset:12288
    ds_read_b64_tr_b16 a[86:87], v32 offset:13312
    v_mfma_f32_32x32x16_bf16 v[96:111], a[60:63], v[180:183], v[96:111]
    v_exp_f32 v112, v112
    v_exp_f32 v113, v113
    v_exp_f32 v114, v114
    v_exp_f32 v115, v115
    v_exp_f32 v116, v116
    v_exp_f32 v117, v117
    v_exp_f32 v118, v118
    v_exp_f32 v119, v119
    v_exp_f32 v120, v120
    ds_read_b64_tr_b16 a[88:89], v33 offset:12288
    ds_read_b64_tr_b16 a[90:91], v33 offset:13312
    s_waitcnt lgkmcnt(10)
    v_mfma_f32_32x32x16_bf16 v[48:63], a[64:67], v[192:195], v[48:63]
    v_exp_f32 v121, v121
    v_exp_f32 v122, v122
    v_exp_f32 v123, v123
    v_exp_f32 v124, v124
    v_exp_f32 v125, v125
    v_exp_f32 v126, v126
    v_exp_f32 v127, v127
    s_nop 0
    v_add_f32 v40, v40, v112
    ds_read_b64_tr_b16 a[92:93], v34 offset:12288
    ds_read_b64_tr_b16 a[94:95], v34 offset:13312
    v_mfma_f32_32x32x16_bf16 v[64:79], a[68:71], v[192:195], v[64:79]
    v_add_f32 v0, v0, v113
    v_add_f32 v40, v40, v114
    v_add_f32 v0, v0, v115
    v_add_f32 v40, v40, v116
    v_add_f32 v0, v0, v117
    v_add_f32 v40, v40, v118
    v_add_f32 v0, v0, v119
    v_add_f32 v40, v40, v120
    v_add_f32 v0, v0, v121
    v_add_u32 v248, 98304, v19
    v_add_u32 v249, 98304, v20
    v_add_u32 v250, 98304, v21
    v_add_u32 v251, 98304, v22
    ds_read_b64_tr_b16 a[32:33], v248 offset:0
    ds_read_b64_tr_b16 a[34:35], v248 offset:1024
    s_waitcnt lgkmcnt(10)
    v_mfma_f32_32x32x16_bf16 v[80:95], a[72:75], v[192:195], v[80:95]
    v_add_f32 v40, v40, v122
    v_add_f32 v0, v0, v123
    v_add_f32 v40, v40, v124
    v_add_f32 v0, v0, v125
    v_add_f32 v40, v40, v126
    v_add_f32 v0, v0, v127
    v_cvt_pk_bf16_f32 v112, v112, v113
    v_cvt_pk_bf16_f32 v113, v114, v115
    v_cvt_pk_bf16_f32 v114, v116, v117
    ds_read_b64_tr_b16 a[36:37], v249 offset:0
    ds_read_b64_tr_b16 a[38:39], v249 offset:1024
    v_mfma_f32_32x32x16_bf16 v[96:111], a[76:79], v[192:195], v[96:111]
    v_cvt_pk_bf16_f32 v115, v118, v119
    v_cvt_pk_bf16_f32 v116, v120, v121
    v_cvt_pk_bf16_f32 v117, v122, v123
    v_cvt_pk_bf16_f32 v118, v124, v125
    v_cvt_pk_bf16_f32 v119, v126, v127
    v_fma_f32 v128, v128, s41, -v41
    v_fma_f32 v129, v129, s41, -v41
    v_fma_f32 v130, v130, s41, -v41
    v_fma_f32 v131, v131, s41, -v41
    ds_read_b64_tr_b16 a[40:41], v250 offset:0
    ds_read_b64_tr_b16 a[42:43], v250 offset:1024
    s_waitcnt lgkmcnt(10)
    v_mfma_f32_32x32x16_bf16 v[48:63], a[80:83], v[196:199], v[48:63]
    v_fma_f32 v132, v132, s41, -v41
    v_fma_f32 v133, v133, s41, -v41
    v_fma_f32 v134, v134, s41, -v41
    v_fma_f32 v135, v135, s41, -v41
    v_fma_f32 v136, v136, s41, -v41
    v_fma_f32 v137, v137, s41, -v41
    v_fma_f32 v138, v138, s41, -v41
    v_fma_f32 v139, v139, s41, -v41
    v_fma_f32 v140, v140, s41, -v41
    ds_read_b64_tr_b16 a[44:45], v251 offset:0
    ds_read_b64_tr_b16 a[46:47], v251 offset:1024
    v_mfma_f32_32x32x16_bf16 v[64:79], a[84:87], v[196:199], v[64:79]
    v_fma_f32 v141, v141, s41, -v41
    v_fma_f32 v142, v142, s41, -v41
    v_fma_f32 v143, v143, s41, -v41
    v_exp_f32 v128, v128
    v_exp_f32 v129, v129
    v_exp_f32 v130, v130
    v_exp_f32 v131, v131
    v_exp_f32 v132, v132
    v_exp_f32 v133, v133
    ds_read_b64_tr_b16 a[48:49], v248 offset:4096
    ds_read_b64_tr_b16 a[50:51], v248 offset:5120
    s_waitcnt lgkmcnt(10)
    v_mfma_f32_32x32x16_bf16 v[80:95], a[88:91], v[196:199], v[80:95]
    v_exp_f32 v134, v134
    v_exp_f32 v135, v135
    v_exp_f32 v136, v136
    v_exp_f32 v137, v137
    v_exp_f32 v138, v138
    v_exp_f32 v139, v139
    v_exp_f32 v140, v140
    v_exp_f32 v141, v141
    v_exp_f32 v142, v142
    ds_read_b64_tr_b16 a[52:53], v249 offset:4096
    ds_read_b64_tr_b16 a[54:55], v249 offset:5120
    v_mfma_f32_32x32x16_bf16 v[96:111], a[92:95], v[196:199], v[96:111]
    v_exp_f32 v143, v143
    s_nop 0
    v_add_f32 v40, v40, v128
    v_add_f32 v0, v0, v129
    v_add_f32 v40, v40, v130
    v_add_f32 v0, v0, v131
    v_add_f32 v40, v40, v132
    v_add_f32 v0, v0, v133
    v_add_f32 v40, v40, v134
    ds_read_b64_tr_b16 a[56:57], v250 offset:4096
    ds_read_b64_tr_b16 a[58:59], v250 offset:5120
    s_waitcnt lgkmcnt(10)
    v_mfma_f32_32x32x16_bf16 v[48:63], a[32:35], v[208:211], v[48:63]
    v_add_f32 v0, v0, v135
    v_add_f32 v40, v40, v136
    v_add_f32 v0, v0, v137
    v_add_f32 v40, v40, v138
    v_add_f32 v0, v0, v139
    v_add_f32 v40, v40, v140
    v_add_f32 v0, v0, v141
    v_add_f32 v40, v40, v142
    v_add_f32 v0, v0, v143
    ds_read_b64_tr_b16 a[60:61], v251 offset:4096
    ds_read_b64_tr_b16 a[62:63], v251 offset:5120
    v_mfma_f32_32x32x16_bf16 v[64:79], a[36:39], v[208:211], v[64:79]
    v_cvt_pk_bf16_f32 v128, v128, v129
    v_cvt_pk_bf16_f32 v129, v130, v131
    v_cvt_pk_bf16_f32 v130, v132, v133
    v_cvt_pk_bf16_f32 v131, v134, v135
    v_cvt_pk_bf16_f32 v132, v136, v137
    v_cvt_pk_bf16_f32 v133, v138, v139
    v_cvt_pk_bf16_f32 v134, v140, v141
    v_cvt_pk_bf16_f32 v135, v142, v143
    v_fma_f32 v144, v144, s41, -v41
    ds_read_b64_tr_b16 a[64:65], v248 offset:8192
    ds_read_b64_tr_b16 a[66:67], v248 offset:9216
    s_waitcnt lgkmcnt(10)
    v_mfma_f32_32x32x16_bf16 v[80:95], a[40:43], v[208:211], v[80:95]
    v_fma_f32 v145, v145, s41, -v41
    v_fma_f32 v146, v146, s41, -v41
    v_fma_f32 v147, v147, s41, -v41
    v_fma_f32 v148, v148, s41, -v41
    v_fma_f32 v149, v149, s41, -v41
    v_fma_f32 v150, v150, s41, -v41
    v_fma_f32 v151, v151, s41, -v41
    v_fma_f32 v152, v152, s41, -v41
    v_fma_f32 v153, v153, s41, -v41
    ds_read_b64_tr_b16 a[68:69], v249 offset:8192
    ds_read_b64_tr_b16 a[70:71], v249 offset:9216
    v_mfma_f32_32x32x16_bf16 v[96:111], a[44:47], v[208:211], v[96:111]
    v_fma_f32 v154, v154, s41, -v41
    v_fma_f32 v155, v155, s41, -v41
    v_fma_f32 v156, v156, s41, -v41
    v_fma_f32 v157, v157, s41, -v41
    v_fma_f32 v158, v158, s41, -v41
    v_fma_f32 v159, v159, s41, -v41
    v_exp_f32 v144, v144
    v_exp_f32 v145, v145
    v_exp_f32 v146, v146
    ds_read_b64_tr_b16 a[72:73], v250 offset:8192
    ds_read_b64_tr_b16 a[74:75], v250 offset:9216
    s_waitcnt lgkmcnt(10)
    v_mfma_f32_32x32x16_bf16 v[48:63], a[48:51], v[212:215], v[48:63]
    v_exp_f32 v147, v147
    v_exp_f32 v148, v148
    v_exp_f32 v149, v149
    v_exp_f32 v150, v150
    v_exp_f32 v151, v151
    v_exp_f32 v152, v152
    v_exp_f32 v153, v153
    v_exp_f32 v154, v154
    v_exp_f32 v155, v155
    ds_read_b64_tr_b16 a[76:77], v251 offset:8192
    ds_read_b64_tr_b16 a[78:79], v251 offset:9216
    v_mfma_f32_32x32x16_bf16 v[64:79], a[52:55], v[212:215], v[64:79]
    v_exp_f32 v156, v156
    v_exp_f32 v157, v157
    v_exp_f32 v158, v158
    v_exp_f32 v159, v159
    s_nop 0
    v_add_f32 v40, v40, v144
    v_add_f32 v0, v0, v145
    v_add_f32 v40, v40, v146
    v_add_f32 v0, v0, v147
    ds_read_b64_tr_b16 a[80:81], v248 offset:12288
    ds_read_b64_tr_b16 a[82:83], v248 offset:13312
    s_waitcnt lgkmcnt(10)
    v_mfma_f32_32x32x16_bf16 v[80:95], a[56:59], v[212:215], v[80:95]
    v_add_f32 v40, v40, v148
    v_add_f32 v0, v0, v149
    v_add_f32 v40, v40, v150
    v_add_f32 v0, v0, v151
    v_add_f32 v40, v40, v152
    v_add_f32 v0, v0, v153
    v_add_f32 v40, v40, v154
    v_add_f32 v0, v0, v155
    v_add_f32 v40, v40, v156
    ds_read_b64_tr_b16 a[84:85], v249 offset:12288
    ds_read_b64_tr_b16 a[86:87], v249 offset:13312
    v_mfma_f32_32x32x16_bf16 v[96:111], a[60:63], v[212:215], v[96:111]
    v_add_f32 v0, v0, v157
    v_add_f32 v40, v40, v158
    v_add_f32 v0, v0, v159
    v_cvt_pk_bf16_f32 v144, v144, v145
    v_cvt_pk_bf16_f32 v145, v146, v147
    v_cvt_pk_bf16_f32 v146, v148, v149
    v_cvt_pk_bf16_f32 v147, v150, v151
    v_cvt_pk_bf16_f32 v148, v152, v153
    v_cvt_pk_bf16_f32 v149, v154, v155
    ds_read_b64_tr_b16 a[88:89], v250 offset:12288
    ds_read_b64_tr_b16 a[90:91], v250 offset:13312
    s_waitcnt lgkmcnt(10)
    v_mfma_f32_32x32x16_bf16 v[48:63], a[64:67], v[224:227], v[48:63]
    v_cvt_pk_bf16_f32 v150, v156, v157
    v_cvt_pk_bf16_f32 v151, v158, v159
    v_fma_f32 v160, v160, s41, -v41
    v_fma_f32 v161, v161, s41, -v41
    v_fma_f32 v162, v162, s41, -v41
    v_fma_f32 v163, v163, s41, -v41
    v_fma_f32 v164, v164, s41, -v41
    v_fma_f32 v165, v165, s41, -v41
    v_fma_f32 v166, v166, s41, -v41
    ds_read_b64_tr_b16 a[92:93], v251 offset:12288
    ds_read_b64_tr_b16 a[94:95], v251 offset:13312
    v_mfma_f32_32x32x16_bf16 v[64:79], a[68:71], v[224:227], v[64:79]
    v_fma_f32 v167, v167, s41, -v41
    v_fma_f32 v168, v168, s41, -v41
    v_fma_f32 v169, v169, s41, -v41
    v_fma_f32 v170, v170, s41, -v41
    v_fma_f32 v171, v171, s41, -v41
    v_fma_f32 v172, v172, s41, -v41
    v_fma_f32 v173, v173, s41, -v41
    v_fma_f32 v174, v174, s41, -v41
    v_fma_f32 v175, v175, s41, -v41
    v_add_u32 v31, 65536, v23
    v_add_u32 v32, 65536, v24
    v_add_u32 v33, 65536, v25
    v_add_u32 v34, 65536, v26
    v_add_u32 v35, 65536, v27
    v_add_u32 v36, 65536, v28
    v_add_u32 v37, 65536, v29
    v_add_u32 v38, 65536, v30
    ds_read_b128 a[32:35], v31 offset:0
    s_waitcnt lgkmcnt(9)
    v_mfma_f32_32x32x16_bf16 v[80:95], a[72:75], v[224:227], v[80:95]
    v_exp_f32 v160, v160
    v_exp_f32 v161, v161
    v_exp_f32 v162, v162
    v_exp_f32 v163, v163
    v_exp_f32 v164, v164
    v_exp_f32 v165, v165
    v_exp_f32 v166, v166
    v_exp_f32 v167, v167
    v_exp_f32 v168, v168
    ds_read_b128 a[36:39], v32 offset:0
    v_mfma_f32_32x32x16_bf16 v[96:111], a[76:79], v[224:227], v[96:111]
    v_exp_f32 v169, v169
    v_exp_f32 v170, v170
    v_exp_f32 v171, v171
    v_exp_f32 v172, v172
    v_exp_f32 v173, v173
    v_exp_f32 v174, v174
    v_exp_f32 v175, v175
    s_nop 0
    v_add_f32 v40, v40, v160
    ds_read_b128 a[40:43], v33 offset:0
    s_waitcnt lgkmcnt(7)
    v_mfma_f32_32x32x16_bf16 v[48:63], a[80:83], v[228:231], v[48:63]
    v_add_f32 v0, v0, v161
    v_add_f32 v40, v40, v162
    v_add_f32 v0, v0, v163
    v_add_f32 v40, v40, v164
    v_add_f32 v0, v0, v165
    v_add_f32 v40, v40, v166
    v_add_f32 v0, v0, v167
    v_add_f32 v40, v40, v168
    v_add_f32 v0, v0, v169
    ds_read_b128 a[44:47], v34 offset:0
    v_mfma_f32_32x32x16_bf16 v[64:79], a[84:87], v[228:231], v[64:79]
    v_add_f32 v40, v40, v170
    v_add_f32 v0, v0, v171
    v_add_f32 v40, v40, v172
    v_add_f32 v0, v0, v173
    v_add_f32 v40, v40, v174
    v_add_f32 v0, v0, v175
    v_cvt_pk_bf16_f32 v160, v160, v161
    v_cvt_pk_bf16_f32 v161, v162, v163
    v_cvt_pk_bf16_f32 v162, v164, v165
    ds_read_b128 a[48:51], v35 offset:0
    s_waitcnt lgkmcnt(5)
    v_mfma_f32_32x32x16_bf16 v[80:95], a[88:91], v[228:231], v[80:95]
    v_cvt_pk_bf16_f32 v163, v166, v167
    v_cvt_pk_bf16_f32 v164, v168, v169
    v_cvt_pk_bf16_f32 v165, v170, v171
    v_cvt_pk_bf16_f32 v166, v172, v173
    v_cvt_pk_bf16_f32 v167, v174, v175
    ds_read_b128 a[52:55], v36 offset:0
    v_mfma_f32_32x32x16_bf16 v[96:111], a[92:95], v[228:231], v[96:111]
    ds_read_b128 a[56:59], v37 offset:0
    s_waitcnt lgkmcnt(5)
    v_mfma_f32_32x32x16_bf16 v[176:191], a[32:35], a[0:3], 0
    s_nop 7
    s_nop 7
    v_mul_f32 v48, v48, v42
    ds_read_b128 a[60:63], v38 offset:0
    v_mfma_f32_32x32x16_bf16 v[176:191], a[36:39], a[4:7], v[176:191]
    v_mul_f32 v49, v49, v42
    v_mul_f32 v50, v50, v42
    v_mul_f32 v51, v51, v42
    ds_read_b128 a[64:67], v31 offset:8192
    s_waitcnt lgkmcnt(5)
    v_mfma_f32_32x32x16_bf16 v[176:191], a[40:43], a[8:11], v[176:191]
    v_mul_f32 v52, v52, v42
    v_mul_f32 v53, v53, v42
    v_mul_f32 v54, v54, v42
    ds_read_b128 a[68:71], v32 offset:8192
    v_mfma_f32_32x32x16_bf16 v[176:191], a[44:47], a[12:15], v[176:191]
    v_mul_f32 v55, v55, v42
    v_mul_f32 v56, v56, v42
    v_mul_f32 v57, v57, v42
    ds_read_b128 a[72:75], v33 offset:8192
    s_waitcnt lgkmcnt(5)
    v_mfma_f32_32x32x16_bf16 v[176:191], a[48:51], a[16:19], v[176:191]
    v_mul_f32 v58, v58, v42
    v_mul_f32 v59, v59, v42
    v_mul_f32 v60, v60, v42
    ds_read_b128 a[76:79], v34 offset:8192
    v_mfma_f32_32x32x16_bf16 v[176:191], a[52:55], a[20:23], v[176:191]
    v_mul_f32 v61, v61, v42
    v_mul_f32 v62, v62, v42
    v_mul_f32 v63, v63, v42
    ds_read_b128 a[80:83], v35 offset:8192
    s_waitcnt lgkmcnt(5)
    v_mfma_f32_32x32x16_bf16 v[176:191], a[56:59], a[24:27], v[176:191]
    v_mul_f32 v64, v64, v42
    v_mul_f32 v65, v65, v42
    v_mul_f32 v66, v66, v42
    ds_read_b128 a[84:87], v36 offset:8192
    v_mfma_f32_32x32x16_bf16 v[176:191], a[60:63], a[28:31], v[176:191]
    v_mul_f32 v67, v67, v42
    v_mul_f32 v68, v68, v42
    v_mul_f32 v69, v69, v42
    ds_read_b128 a[88:91], v37 offset:8192
    s_waitcnt lgkmcnt(5)
    v_mfma_f32_32x32x16_bf16 v[192:207], a[64:67], a[0:3], 0
    v_mul_f32 v70, v70, v42
    v_mul_f32 v71, v71, v42
    v_mul_f32 v72, v72, v42
    ds_read_b128 a[92:95], v38 offset:8192
    v_mfma_f32_32x32x16_bf16 v[192:207], a[68:71], a[4:7], v[192:207]
    v_mul_f32 v73, v73, v42
    v_mul_f32 v74, v74, v42
    v_mul_f32 v75, v75, v42
    v_add_u32 v248, 114688, v23
    v_add_u32 v249, 114688, v24
    v_add_u32 v250, 114688, v25
    v_add_u32 v251, 114688, v26
    v_add_u32 v252, 114688, v27
    v_add_u32 v253, 114688, v28
    v_add_u32 v254, 114688, v29
    v_add_u32 v255, 114688, v30
    ds_read_b128 a[32:35], v248 offset:0
    s_waitcnt lgkmcnt(5)
    v_mfma_f32_32x32x16_bf16 v[192:207], a[72:75], a[8:11], v[192:207]
    v_mul_f32 v76, v76, v42
    v_mul_f32 v77, v77, v42
    v_mul_f32 v78, v78, v42
    ds_read_b128 a[36:39], v249 offset:0
    v_mfma_f32_32x32x16_bf16 v[192:207], a[76:79], a[12:15], v[192:207]
    v_mul_f32 v79, v79, v42
    v_mul_f32 v80, v80, v42
    v_mul_f32 v81, v81, v42
    ds_read_b128 a[40:43], v250 offset:0
    s_waitcnt lgkmcnt(5)
    v_mfma_f32_32x32x16_bf16 v[192:207], a[80:83], a[16:19], v[192:207]
    v_mul_f32 v82, v82, v42
    v_mul_f32 v83, v83, v42
    v_mul_f32 v84, v84, v42
    ds_read_b128 a[44:47], v251 offset:0
    v_mfma_f32_32x32x16_bf16 v[192:207], a[84:87], a[20:23], v[192:207]
    v_mul_f32 v85, v85, v42
    v_mul_f32 v86, v86, v42
    v_mul_f32 v87, v87, v42
    ds_read_b128 a[48:51], v252 offset:0
    s_waitcnt lgkmcnt(5)
    v_mfma_f32_32x32x16_bf16 v[192:207], a[88:91], a[24:27], v[192:207]
    v_mul_f32 v88, v88, v42
    v_mul_f32 v89, v89, v42
    v_mul_f32 v90, v90, v42
    ds_read_b128 a[52:55], v253 offset:0
    v_mfma_f32_32x32x16_bf16 v[192:207], a[92:95], a[28:31], v[192:207]
    v_mul_f32 v91, v91, v42
    v_mul_f32 v92, v92, v42
    v_mul_f32 v93, v93, v42
    ds_read_b128 a[56:59], v254 offset:0
    s_waitcnt lgkmcnt(5)
    v_mfma_f32_32x32x16_bf16 v[208:223], a[32:35], a[0:3], 0
    v_mul_f32 v94, v94, v42
    v_mul_f32 v95, v95, v42
    v_mul_f32 v96, v96, v42
    ds_read_b128 a[60:63], v255 offset:0
    v_mfma_f32_32x32x16_bf16 v[208:223], a[36:39], a[4:7], v[208:223]
    v_mul_f32 v97, v97, v42
    v_mul_f32 v98, v98, v42
    v_mul_f32 v99, v99, v42
    ds_read_b128 a[64:67], v248 offset:8192
    s_waitcnt lgkmcnt(5)
    v_mfma_f32_32x32x16_bf16 v[208:223], a[40:43], a[8:11], v[208:223]
    v_mul_f32 v100, v100, v42
    v_mul_f32 v101, v101, v42
    v_mul_f32 v102, v102, v42
    ds_read_b128 a[68:71], v249 offset:8192
    v_mfma_f32_32x32x16_bf16 v[208:223], a[44:47], a[12:15], v[208:223]
    v_mul_f32 v103, v103, v42
    v_mul_f32 v104, v104, v42
    v_mul_f32 v105, v105, v42
    ds_read_b128 a[72:75], v250 offset:8192
    s_waitcnt lgkmcnt(5)
    v_mfma_f32_32x32x16_bf16 v[208:223], a[48:51], a[16:19], v[208:223]
    v_mul_f32 v106, v106, v42
    v_mul_f32 v107, v107, v42
    v_mul_f32 v108, v108, v42
    ds_read_b128 a[76:79], v251 offset:8192
    v_mfma_f32_32x32x16_bf16 v[208:223], a[52:55], a[20:23], v[208:223]
    v_mul_f32 v109, v109, v42
    v_mul_f32 v110, v110, v42
    v_mul_f32 v111, v111, v42
    ds_read_b128 a[80:83], v252 offset:8192
    s_waitcnt lgkmcnt(5)
    v_mfma_f32_32x32x16_bf16 v[208:223], a[56:59], a[24:27], v[208:223]
    ds_read_b128 a[84:87], v253 offset:8192
    v_mfma_f32_32x32x16_bf16 v[208:223], a[60:63], a[28:31], v[208:223]
    ds_read_b128 a[88:91], v254 offset:8192
    s_waitcnt lgkmcnt(5)
    v_mfma_f32_32x32x16_bf16 v[224:239], a[64:67], a[0:3], 0
    ds_read_b128 a[92:95], v255 offset:8192
    v_mfma_f32_32x32x16_bf16 v[224:239], a[68:71], a[4:7], v[224:239]
    s_waitcnt lgkmcnt(4)
    v_mfma_f32_32x32x16_bf16 v[224:239], a[72:75], a[8:11], v[224:239]
    v_mfma_f32_32x32x16_bf16 v[224:239], a[76:79], a[12:15], v[224:239]
    s_waitcnt lgkmcnt(2)
    v_mfma_f32_32x32x16_bf16 v[224:239], a[80:83], a[16:19], v[224:239]
    v_mfma_f32_32x32x16_bf16 v[224:239], a[84:87], a[20:23], v[224:239]
    s_waitcnt lgkmcnt(0)
    v_mfma_f32_32x32x16_bf16 v[224:239], a[88:91], a[24:27], v[224:239]
    v_mfma_f32_32x32x16_bf16 v[224:239], a[92:95], a[28:31], v[224:239]
    s_waitcnt vmcnt(0) lgkmcnt(0)
    s_barrier
    s_cmp_lt_u32 s32, 2
    s_mov_b32 s36, 147456
    s_cselect_b32 s53, s36, 16384
    s_and_b32 s36, s32, 1
    s_lshl_b32 s36, s36, 13
    s_add_u32 s53, s53, s36
    s_lshl_b32 s36, s2, 2
    s_add_u32 s36, s36, s32
    s_and_b32 s37, s36, 7
    s_lshr_b32 s36, s36, 3
    s_mul_i32 s37, s37, 160
    s_mul_i32 s36, s36, 40960
    s_add_u32 s38, s36, s37
    s_mov_b32 s36, 52429
    s_movk_i32 s37, 1280
    s_movk_i32 s39, 10
    v_add_u32 v245, 0, v1
    v_mul_lo_u32 v246, v245, s36
    v_lshrrev_b32 v246, 19, v246
    v_mul_lo_u32 v247, v246, s39
    v_sub_u32 v247, v245, v247
    v_mul_lo_u32 v246, v246, s37
    v_lshl_add_u32 v240, v247, 4, v246
    v_add_u32 v245, 64, v1
    v_mul_lo_u32 v246, v245, s36
    v_lshrrev_b32 v246, 19, v246
    v_mul_lo_u32 v247, v246, s39
    v_sub_u32 v247, v245, v247
    v_mul_lo_u32 v246, v246, s37
    v_lshl_add_u32 v241, v247, 4, v246
    v_add_u32 v245, 128, v1
    v_mul_lo_u32 v246, v245, s36
    v_lshrrev_b32 v246, 19, v246
    v_mul_lo_u32 v247, v246, s39
    v_sub_u32 v247, v245, v247
    v_mul_lo_u32 v246, v246, s37
    v_lshl_add_u32 v242, v247, 4, v246
    v_add_u32 v245, 192, v1
    v_mul_lo_u32 v246, v245, s36
    v_lshrrev_b32 v246, 19, v246
    v_mul_lo_u32 v247, v246, s39
    v_sub_u32 v247, v245, v247
    v_mul_lo_u32 v246, v246, s37
    v_lshl_add_u32 v243, v247, 4, v246
    v_add_u32 v245, 256, v1
    v_mul_lo_u32 v246, v245, s36
    v_lshrrev_b32 v246, 19, v246
    v_mul_lo_u32 v247, v246, s39
    v_sub_u32 v247, v245, v247
    v_mul_lo_u32 v246, v246, s37
    v_lshl_add_u32 v244, v247, 4, v246
    s_add_u32 m0, s53, 0
    s_nop 0
    buffer_load_dwordx4 v240, s[28:31], s38 offen nt lds
    s_add_u32 m0, s53, 1024
    s_nop 0
    buffer_load_dwordx4 v241, s[28:31], s38 offen nt lds
    s_add_u32 m0, s53, 2048
    s_nop 0
    buffer_load_dwordx4 v242, s[28:31], s38 offen nt lds
    s_add_u32 m0, s53, 3072
    s_nop 0
    buffer_load_dwordx4 v243, s[28:31], s38 offen nt lds
    s_add_u32 m0, s53, 4096
    s_nop 0
    buffer_load_dwordx4 v244, s[28:31], s38 offen nt lds
    v_add_u32 v31, 0, v19
    v_add_u32 v32, 0, v20
    v_add_u32 v33, 0, v21
    v_add_u32 v34, 0, v22
    ds_read_b64_tr_b16 a[32:33], v31 offset:0
    ds_read_b64_tr_b16 a[34:35], v31 offset:1024
    ds_read_b64_tr_b16 a[36:37], v32 offset:0
    ds_read_b64_tr_b16 a[38:39], v32 offset:1024
    ds_read_b64_tr_b16 a[40:41], v33 offset:0
    ds_read_b64_tr_b16 a[42:43], v33 offset:1024
    ds_read_b64_tr_b16 a[44:45], v34 offset:0
    ds_read_b64_tr_b16 a[46:47], v34 offset:1024
    ds_read_b64_tr_b16 a[48:49], v31 offset:4096
    ds_read_b64_tr_b16 a[50:51], v31 offset:5120
    ds_read_b64_tr_b16 a[52:53], v32 offset:4096
    ds_read_b64_tr_b16 a[54:55], v32 offset:5120
    ds_read_b64_tr_b16 a[56:57], v33 offset:4096
    ds_read_b64_tr_b16 a[58:59], v33 offset:5120
    s_waitcnt lgkmcnt(10)
    v_mfma_f32_32x32x16_bf16 v[48:63], a[32:35], v[112:115], v[48:63]
    v_max3_f32 v43, v176, v177, v178
    v_max3_f32 v43, v43, v179, v180
    v_max3_f32 v43, v43, v181, v182
    v_max3_f32 v43, v43, v183, v184
    v_max3_f32 v43, v43, v185, v186
    v_max3_f32 v43, v43, v187, v188
    v_max3_f32 v43, v43, v189, v190
    v_max_f32 v43, v43, v191
    v_max3_f32 v44, v192, v193, v194
    ds_read_b64_tr_b16 a[60:61], v34 offset:4096
    ds_read_b64_tr_b16 a[62:63], v34 offset:5120
    v_mfma_f32_32x32x16_bf16 v[64:79], a[36:39], v[112:115], v[64:79]
    v_max3_f32 v44, v44, v195, v196
    v_max3_f32 v44, v44, v197, v198
    v_max3_f32 v44, v44, v199, v200
    v_max3_f32 v44, v44, v201, v202
    v_max3_f32 v44, v44, v203, v204
    v_max3_f32 v44, v44, v205, v206
    v_max_f32 v44, v44, v207
    v_max3_f32 v45, v208, v209, v210
    v_max3_f32 v45, v45, v211, v212
    ds_read_b64_tr_b16 a[64:65], v31 offset:8192
    ds_read_b64_tr_b16 a[66:67], v31 offset:9216
    s_waitcnt lgkmcnt(10)
    v_mfma_f32_32x32x16_bf16 v[80:95], a[40:43], v[112:115], v[80:95]
    v_max3_f32 v45, v45, v213, v214
    v_max3_f32 v45, v45, v215, v216
    v_max3_f32 v45, v45, v217, v218
    v_max3_f32 v45, v45, v219, v220
    v_max3_f32 v45, v45, v221, v222
    v_max_f32 v45, v45, v223
    v_max3_f32 v46, v224, v225, v226
    v_max3_f32 v46, v46, v227, v228
    v_max3_f32 v46, v46, v229, v230
    ds_read_b64_tr_b16 a[68:69], v32 offset:8192
    ds_read_b64_tr_b16 a[70:71], v32 offset:9216
    v_mfma_f32_32x32x16_bf16 v[96:111], a[44:47], v[112:115], v[96:111]
    v_max3_f32 v46, v46, v231, v232
    v_max3_f32 v46, v46, v233, v234
    v_max3_f32 v46, v46, v235, v236
    v_max3_f32 v46, v46, v237, v238
    v_max_f32 v46, v46, v239
    v_max3_f32 v43, v43, v44, v45
    v_max_f32 v43, v43, v46
    v_mov_b32 v44, v43
    s_nop 1
    ds_read_b64_tr_b16 a[72:73], v33 offset:8192
    ds_read_b64_tr_b16 a[74:75], v33 offset:9216
    s_waitcnt lgkmcnt(10)
    v_mfma_f32_32x32x16_bf16 v[48:63], a[48:51], v[116:119], v[48:63]
    v_permlane32_swap_b32 v43, v44
    v_max_f32 v43, v43, v44
    v_max_f32 v43, v43, v39
    v_sub_f32 v44, v39, v43
    v_mul_f32 v44, s41, v44
    v_exp_f32 v42, v44
    v_mov_b32 v39, v43
    s_nop 0
    v_mul_f32 v40, v40, v42
    ds_read_b64_tr_b16 a[76:77], v34 offset:8192
    ds_read_b64_tr_b16 a[78:79], v34 offset:9216
    v_mfma_f32_32x32x16_bf16 v[64:79], a[52:55], v[116:119], v[64:79]
    v_mul_f32 v0, v0, v42
    v_mul_f32 v41, s41, v39
    v_fma_f32 v176, v176, s41, -v41
    v_fma_f32 v177, v177, s41, -v41
    v_fma_f32 v178, v178, s41, -v41
    v_fma_f32 v179, v179, s41, -v41
    v_fma_f32 v180, v180, s41, -v41
    v_fma_f32 v181, v181, s41, -v41
    v_fma_f32 v182, v182, s41, -v41
    ds_read_b64_tr_b16 a[80:81], v31 offset:12288
    ds_read_b64_tr_b16 a[82:83], v31 offset:13312
    s_waitcnt lgkmcnt(10)
    v_mfma_f32_32x32x16_bf16 v[80:95], a[56:59], v[116:119], v[80:95]
    v_fma_f32 v183, v183, s41, -v41
    v_fma_f32 v184, v184, s41, -v41
    v_fma_f32 v185, v185, s41, -v41
    v_fma_f32 v186, v186, s41, -v41
    v_fma_f32 v187, v187, s41, -v41
    v_fma_f32 v188, v188, s41, -v41
    v_fma_f32 v189, v189, s41, -v41
    v_fma_f32 v190, v190, s41, -v41
    v_fma_f32 v191, v191, s41, -v41
    ds_read_b64_tr_b16 a[84:85], v32 offset:12288
    ds_read_b64_tr_b16 a[86:87], v32 offset:13312
    v_mfma_f32_32x32x16_bf16 v[96:111], a[60:63], v[116:119], v[96:111]
    v_exp_f32 v176, v176
    v_exp_f32 v177, v177
    v_exp_f32 v178, v178
    v_exp_f32 v179, v179
    v_exp_f32 v180, v180
    v_exp_f32 v181, v181
    v_exp_f32 v182, v182
    v_exp_f32 v183, v183
    v_exp_f32 v184, v184
    ds_read_b64_tr_b16 a[88:89], v33 offset:12288
    ds_read_b64_tr_b16 a[90:91], v33 offset:13312
    s_waitcnt lgkmcnt(10)
    v_mfma_f32_32x32x16_bf16 v[48:63], a[64:67], v[128:131], v[48:63]
    v_exp_f32 v185, v185
    v_exp_f32 v186, v186
    v_exp_f32 v187, v187
    v_exp_f32 v188, v188
    v_exp_f32 v189, v189
    v_exp_f32 v190, v190
    v_exp_f32 v191, v191
    s_nop 0
    v_add_f32 v40, v40, v176
    ds_read_b64_tr_b16 a[92:93], v34 offset:12288
    ds_read_b64_tr_b16 a[94:95], v34 offset:13312
    v_mfma_f32_32x32x16_bf16 v[64:79], a[68:71], v[128:131], v[64:79]
    v_add_f32 v0, v0, v177
    v_add_f32 v40, v40, v178
    v_add_f32 v0, v0, v179
    v_add_f32 v40, v40, v180
    v_add_f32 v0, v0, v181
    v_add_f32 v40, v40, v182
    v_add_f32 v0, v0, v183
    v_add_f32 v40, v40, v184
    v_add_f32 v0, v0, v185
    v_add_u32 v248, 49152, v19
    v_add_u32 v249, 49152, v20
    v_add_u32 v250, 49152, v21
    v_add_u32 v251, 49152, v22
    ds_read_b64_tr_b16 a[32:33], v248 offset:0
    ds_read_b64_tr_b16 a[34:35], v248 offset:1024
    s_waitcnt lgkmcnt(10)
    v_mfma_f32_32x32x16_bf16 v[80:95], a[72:75], v[128:131], v[80:95]
    v_add_f32 v40, v40, v186
    v_add_f32 v0, v0, v187
    v_add_f32 v40, v40, v188
    v_add_f32 v0, v0, v189
    v_add_f32 v40, v40, v190
    v_add_f32 v0, v0, v191
    v_cvt_pk_bf16_f32 v176, v176, v177
    v_cvt_pk_bf16_f32 v177, v178, v179
    v_cvt_pk_bf16_f32 v178, v180, v181
    ds_read_b64_tr_b16 a[36:37], v249 offset:0
    ds_read_b64_tr_b16 a[38:39], v249 offset:1024
    v_mfma_f32_32x32x16_bf16 v[96:111], a[76:79], v[128:131], v[96:111]
    v_cvt_pk_bf16_f32 v179, v182, v183
    v_cvt_pk_bf16_f32 v180, v184, v185
    v_cvt_pk_bf16_f32 v181, v186, v187
    v_cvt_pk_bf16_f32 v182, v188, v189
    v_cvt_pk_bf16_f32 v183, v190, v191
    v_fma_f32 v192, v192, s41, -v41
    v_fma_f32 v193, v193, s41, -v41
    v_fma_f32 v194, v194, s41, -v41
    v_fma_f32 v195, v195, s41, -v41
    ds_read_b64_tr_b16 a[40:41], v250 offset:0
    ds_read_b64_tr_b16 a[42:43], v250 offset:1024
    s_waitcnt lgkmcnt(10)
    v_mfma_f32_32x32x16_bf16 v[48:63], a[80:83], v[132:135], v[48:63]
    v_fma_f32 v196, v196, s41, -v41
    v_fma_f32 v197, v197, s41, -v41
    v_fma_f32 v198, v198, s41, -v41
    v_fma_f32 v199, v199, s41, -v41
    v_fma_f32 v200, v200, s41, -v41
    v_fma_f32 v201, v201, s41, -v41
    v_fma_f32 v202, v202, s41, -v41
    v_fma_f32 v203, v203, s41, -v41
    v_fma_f32 v204, v204, s41, -v41
    ds_read_b64_tr_b16 a[44:45], v251 offset:0
    ds_read_b64_tr_b16 a[46:47], v251 offset:1024
    v_mfma_f32_32x32x16_bf16 v[64:79], a[84:87], v[132:135], v[64:79]
    v_fma_f32 v205, v205, s41, -v41
    v_fma_f32 v206, v206, s41, -v41
    v_fma_f32 v207, v207, s41, -v41
    v_exp_f32 v192, v192
    v_exp_f32 v193, v193
    v_exp_f32 v194, v194
    v_exp_f32 v195, v195
    v_exp_f32 v196, v196
    v_exp_f32 v197, v197
    ds_read_b64_tr_b16 a[48:49], v248 offset:4096
    ds_read_b64_tr_b16 a[50:51], v248 offset:5120
    s_waitcnt lgkmcnt(10)
    v_mfma_f32_32x32x16_bf16 v[80:95], a[88:91], v[132:135], v[80:95]
    v_exp_f32 v198, v198
    v_exp_f32 v199, v199
    v_exp_f32 v200, v200
    v_exp_f32 v201, v201
    v_exp_f32 v202, v202
    v_exp_f32 v203, v203
    v_exp_f32 v204, v204
    v_exp_f32 v205, v205
    v_exp_f32 v206, v206
    ds_read_b64_tr_b16 a[52:53], v249 offset:4096
    ds_read_b64_tr_b16 a[54:55], v249 offset:5120
    v_mfma_f32_32x32x16_bf16 v[96:111], a[92:95], v[132:135], v[96:111]
    v_exp_f32 v207, v207
    s_nop 0
    v_add_f32 v40, v40, v192
    v_add_f32 v0, v0, v193
    v_add_f32 v40, v40, v194
    v_add_f32 v0, v0, v195
    v_add_f32 v40, v40, v196
    v_add_f32 v0, v0, v197
    v_add_f32 v40, v40, v198
    ds_read_b64_tr_b16 a[56:57], v250 offset:4096
    ds_read_b64_tr_b16 a[58:59], v250 offset:5120
    s_waitcnt lgkmcnt(10)
    v_mfma_f32_32x32x16_bf16 v[48:63], a[32:35], v[144:147], v[48:63]
    v_add_f32 v0, v0, v199
    v_add_f32 v40, v40, v200
    v_add_f32 v0, v0, v201
    v_add_f32 v40, v40, v202
    v_add_f32 v0, v0, v203
    v_add_f32 v40, v40, v204
    v_add_f32 v0, v0, v205
    v_add_f32 v40, v40, v206
    v_add_f32 v0, v0, v207
    ds_read_b64_tr_b16 a[60:61], v251 offset:4096
    ds_read_b64_tr_b16 a[62:63], v251 offset:5120
    v_mfma_f32_32x32x16_bf16 v[64:79], a[36:39], v[144:147], v[64:79]
    v_cvt_pk_bf16_f32 v192, v192, v193
    v_cvt_pk_bf16_f32 v193, v194, v195
    v_cvt_pk_bf16_f32 v194, v196, v197
    v_cvt_pk_bf16_f32 v195, v198, v199
    v_cvt_pk_bf16_f32 v196, v200, v201
    v_cvt_pk_bf16_f32 v197, v202, v203
    v_cvt_pk_bf16_f32 v198, v204, v205
    v_cvt_pk_bf16_f32 v199, v206, v207
    v_fma_f32 v208, v208, s41, -v41
    ds_read_b64_tr_b16 a[64:65], v248 offset:8192
    ds_read_b64_tr_b16 a[66:67], v248 offset:9216
    s_waitcnt lgkmcnt(10)
    v_mfma_f32_32x32x16_bf16 v[80:95], a[40:43], v[144:147], v[80:95]
    v_fma_f32 v209, v209, s41, -v41
    v_fma_f32 v210, v210, s41, -v41
    v_fma_f32 v211, v211, s41, -v41
    v_fma_f32 v212, v212, s41, -v41
    v_fma_f32 v213, v213, s41, -v41
    v_fma_f32 v214, v214, s41, -v41
    v_fma_f32 v215, v215, s41, -v41
    v_fma_f32 v216, v216, s41, -v41
    v_fma_f32 v217, v217, s41, -v41
    ds_read_b64_tr_b16 a[68:69], v249 offset:8192
    ds_read_b64_tr_b16 a[70:71], v249 offset:9216
    v_mfma_f32_32x32x16_bf16 v[96:111], a[44:47], v[144:147], v[96:111]
    v_fma_f32 v218, v218, s41, -v41
    v_fma_f32 v219, v219, s41, -v41
    v_fma_f32 v220, v220, s41, -v41
    v_fma_f32 v221, v221, s41, -v41
    v_fma_f32 v222, v222, s41, -v41
    v_fma_f32 v223, v223, s41, -v41
    v_exp_f32 v208, v208
    v_exp_f32 v209, v209
    v_exp_f32 v210, v210
    ds_read_b64_tr_b16 a[72:73], v250 offset:8192
    ds_read_b64_tr_b16 a[74:75], v250 offset:9216
    s_waitcnt lgkmcnt(10)
    v_mfma_f32_32x32x16_bf16 v[48:63], a[48:51], v[148:151], v[48:63]
    v_exp_f32 v211, v211
    v_exp_f32 v212, v212
    v_exp_f32 v213, v213
    v_exp_f32 v214, v214
    v_exp_f32 v215, v215
    v_exp_f32 v216, v216
    v_exp_f32 v217, v217
    v_exp_f32 v218, v218
    v_exp_f32 v219, v219
    ds_read_b64_tr_b16 a[76:77], v251 offset:8192
    ds_read_b64_tr_b16 a[78:79], v251 offset:9216
    v_mfma_f32_32x32x16_bf16 v[64:79], a[52:55], v[148:151], v[64:79]
    v_exp_f32 v220, v220
    v_exp_f32 v221, v221
    v_exp_f32 v222, v222
    v_exp_f32 v223, v223
    s_nop 0
    v_add_f32 v40, v40, v208
    v_add_f32 v0, v0, v209
    v_add_f32 v40, v40, v210
    v_add_f32 v0, v0, v211
    ds_read_b64_tr_b16 a[80:81], v248 offset:12288
    ds_read_b64_tr_b16 a[82:83], v248 offset:13312
    s_waitcnt lgkmcnt(10)
    v_mfma_f32_32x32x16_bf16 v[80:95], a[56:59], v[148:151], v[80:95]
    v_add_f32 v40, v40, v212
    v_add_f32 v0, v0, v213
    v_add_f32 v40, v40, v214
    v_add_f32 v0, v0, v215
    v_add_f32 v40, v40, v216
    v_add_f32 v0, v0, v217
    v_add_f32 v40, v40, v218
    v_add_f32 v0, v0, v219
    v_add_f32 v40, v40, v220
    ds_read_b64_tr_b16 a[84:85], v249 offset:12288
    ds_read_b64_tr_b16 a[86:87], v249 offset:13312
    v_mfma_f32_32x32x16_bf16 v[96:111], a[60:63], v[148:151], v[96:111]
    v_add_f32 v0, v0, v221
    v_add_f32 v40, v40, v222
    v_add_f32 v0, v0, v223
    v_cvt_pk_bf16_f32 v208, v208, v209
    v_cvt_pk_bf16_f32 v209, v210, v211
    v_cvt_pk_bf16_f32 v210, v212, v213
    v_cvt_pk_bf16_f32 v211, v214, v215
    v_cvt_pk_bf16_f32 v212, v216, v217
    v_cvt_pk_bf16_f32 v213, v218, v219
    ds_read_b64_tr_b16 a[88:89], v250 offset:12288
    ds_read_b64_tr_b16 a[90:91], v250 offset:13312
    s_waitcnt lgkmcnt(10)
    v_mfma_f32_32x32x16_bf16 v[48:63], a[64:67], v[160:163], v[48:63]
    v_cvt_pk_bf16_f32 v214, v220, v221
    v_cvt_pk_bf16_f32 v215, v222, v223
    v_fma_f32 v224, v224, s41, -v41
    v_fma_f32 v225, v225, s41, -v41
    v_fma_f32 v226, v226, s41, -v41
    v_fma_f32 v227, v227, s41, -v41
    v_fma_f32 v228, v228, s41, -v41
    v_fma_f32 v229, v229, s41, -v41
    v_fma_f32 v230, v230, s41, -v41
    ds_read_b64_tr_b16 a[92:93], v251 offset:12288
    ds_read_b64_tr_b16 a[94:95], v251 offset:13312
    v_mfma_f32_32x32x16_bf16 v[64:79], a[68:71], v[160:163], v[64:79]
    v_fma_f32 v231, v231, s41, -v41
    v_fma_f32 v232, v232, s41, -v41
    v_fma_f32 v233, v233, s41, -v41
    v_fma_f32 v234, v234, s41, -v41
    v_fma_f32 v235, v235, s41, -v41
    v_fma_f32 v236, v236, s41, -v41
    v_fma_f32 v237, v237, s41, -v41
    v_fma_f32 v238, v238, s41, -v41
    v_fma_f32 v239, v239, s41, -v41
    v_add_u32 v31, 131072, v19
    v_add_u32 v32, 131072, v20
    v_add_u32 v33, 131072, v21
    v_add_u32 v34, 131072, v22
    ds_read_b64_tr_b16 a[32:33], v31 offset:0
    ds_read_b64_tr_b16 a[34:35], v31 offset:1024
    s_waitcnt lgkmcnt(10)
    v_mfma_f32_32x32x16_bf16 v[80:95], a[72:75], v[160:163], v[80:95]
    v_exp_f32 v224, v224
    v_exp_f32 v225, v225
    v_exp_f32 v226, v226
    v_exp_f32 v227, v227
    v_exp_f32 v228, v228
    v_exp_f32 v229, v229
    v_exp_f32 v230, v230
    v_exp_f32 v231, v231
    v_exp_f32 v232, v232
    ds_read_b64_tr_b16 a[36:37], v32 offset:0
    ds_read_b64_tr_b16 a[38:39], v32 offset:1024
    v_mfma_f32_32x32x16_bf16 v[96:111], a[76:79], v[160:163], v[96:111]
    v_exp_f32 v233, v233
    v_exp_f32 v234, v234
    v_exp_f32 v235, v235
    v_exp_f32 v236, v236
    v_exp_f32 v237, v237
    v_exp_f32 v238, v238
    v_exp_f32 v239, v239
    s_nop 0
    v_add_f32 v40, v40, v224
    ds_read_b64_tr_b16 a[40:41], v33 offset:0
    ds_read_b64_tr_b16 a[42:43], v33 offset:1024
    s_waitcnt lgkmcnt(10)
    v_mfma_f32_32x32x16_bf16 v[48:63], a[80:83], v[164:167], v[48:63]
    v_add_f32 v0, v0, v225
    v_add_f32 v40, v40, v226
    v_add_f32 v0, v0, v227
    v_add_f32 v40, v40, v228
    v_add_f32 v0, v0, v229
    v_add_f32 v40, v40, v230
    v_add_f32 v0, v0, v231
    v_add_f32 v40, v40, v232
    v_add_f32 v0, v0, v233
    ds_read_b64_tr_b16 a[44:45], v34 offset:0
    ds_read_b64_tr_b16 a[46:47], v34 offset:1024
    v_mfma_f32_32x32x16_bf16 v[64:79], a[84:87], v[164:167], v[64:79]
    v_add_f32 v40, v40, v234
    v_add_f32 v0, v0, v235
    v_add_f32 v40, v40, v236
    v_add_f32 v0, v0, v237
    v_add_f32 v40, v40, v238
    v_add_f32 v0, v0, v239
    v_cvt_pk_bf16_f32 v224, v224, v225
    v_cvt_pk_bf16_f32 v225, v226, v227
    v_cvt_pk_bf16_f32 v226, v228, v229
    ds_read_b64_tr_b16 a[48:49], v31 offset:4096
    ds_read_b64_tr_b16 a[50:51], v31 offset:5120
    s_waitcnt lgkmcnt(10)
    v_mfma_f32_32x32x16_bf16 v[80:95], a[88:91], v[164:167], v[80:95]
    v_cvt_pk_bf16_f32 v227, v230, v231
    v_cvt_pk_bf16_f32 v228, v232, v233
    v_cvt_pk_bf16_f32 v229, v234, v235
    v_cvt_pk_bf16_f32 v230, v236, v237
    v_cvt_pk_bf16_f32 v231, v238, v239
    ds_read_b64_tr_b16 a[52:53], v32 offset:4096
    ds_read_b64_tr_b16 a[54:55], v32 offset:5120
    v_mfma_f32_32x32x16_bf16 v[96:111], a[92:95], v[164:167], v[96:111]
    s_nop 7
    s_nop 7
    v_mul_f32 v48, v48, v42
    v_mul_f32 v49, v49, v42
    v_mul_f32 v50, v50, v42
    v_mul_f32 v51, v51, v42
    v_mul_f32 v52, v52, v42
    v_mul_f32 v53, v53, v42
    v_mul_f32 v54, v54, v42
    v_mul_f32 v55, v55, v42
    v_mul_f32 v56, v56, v42
    v_mul_f32 v57, v57, v42
    v_mul_f32 v58, v58, v42
    v_mul_f32 v59, v59, v42
    v_mul_f32 v60, v60, v42
    v_mul_f32 v61, v61, v42
    v_mul_f32 v62, v62, v42
    v_mul_f32 v63, v63, v42
    v_mul_f32 v64, v64, v42
    v_mul_f32 v65, v65, v42
    v_mul_f32 v66, v66, v42
    v_mul_f32 v67, v67, v42
    v_mul_f32 v68, v68, v42
    v_mul_f32 v69, v69, v42
    v_mul_f32 v70, v70, v42
    v_mul_f32 v71, v71, v42
    v_mul_f32 v72, v72, v42
    v_mul_f32 v73, v73, v42
    v_mul_f32 v74, v74, v42
    v_mul_f32 v75, v75, v42
    v_mul_f32 v76, v76, v42
    v_mul_f32 v77, v77, v42
    v_mul_f32 v78, v78, v42
    v_mul_f32 v79, v79, v42
    v_mul_f32 v80, v80, v42
    v_mul_f32 v81, v81, v42
    v_mul_f32 v82, v82, v42
    v_mul_f32 v83, v83, v42
    v_mul_f32 v84, v84, v42
    v_mul_f32 v85, v85, v42
    v_mul_f32 v86, v86, v42
    v_mul_f32 v87, v87, v42
    v_mul_f32 v88, v88, v42
    v_mul_f32 v89, v89, v42
    v_mul_f32 v90, v90, v42
    v_mul_f32 v91, v91, v42
    v_mul_f32 v92, v92, v42
    v_mul_f32 v93, v93, v42
    v_mul_f32 v94, v94, v42
    v_mul_f32 v95, v95, v42
    v_mul_f32 v96, v96, v42
    v_mul_f32 v97, v97, v42
    v_mul_f32 v98, v98, v42
    v_mul_f32 v99, v99, v42
    v_mul_f32 v100, v100, v42
    v_mul_f32 v101, v101, v42
    v_mul_f32 v102, v102, v42
    v_mul_f32 v103, v103, v42
    v_mul_f32 v104, v104, v42
    v_mul_f32 v105, v105, v42
    v_mul_f32 v106, v106, v42
    v_mul_f32 v107, v107, v42
    v_mul_f32 v108, v108, v42
    v_mul_f32 v109, v109, v42
    v_mul_f32 v110, v110, v42
    v_mul_f32 v111, v111, v42
    s_nop 1
    ds_read_b64_tr_b16 a[56:57], v33 offset:4096
    ds_read_b64_tr_b16 a[58:59], v33 offset:5120
    s_waitcnt lgkmcnt(10)
    v_mfma_f32_32x32x16_bf16 v[48:63], a[32:35], v[176:179], v[48:63]
    ds_read_b64_tr_b16 a[60:61], v34 offset:4096
    ds_read_b64_tr_b16 a[62:63], v34 offset:5120
    v_mfma_f32_32x32x16_bf16 v[64:79], a[36:39], v[176:179], v[64:79]
    ds_read_b64_tr_b16 a[64:65], v31 offset:8192
    ds_read_b64_tr_b16 a[66:67], v31 offset:9216
    s_waitcnt lgkmcnt(10)
    v_mfma_f32_32x32x16_bf16 v[80:95], a[40:43], v[176:179], v[80:95]
    ds_read_b64_tr_b16 a[68:69], v32 offset:8192
    ds_read_b64_tr_b16 a[70:71], v32 offset:9216
    v_mfma_f32_32x32x16_bf16 v[96:111], a[44:47], v[176:179], v[96:111]
    ds_read_b64_tr_b16 a[72:73], v33 offset:8192
    ds_read_b64_tr_b16 a[74:75], v33 offset:9216
    s_waitcnt lgkmcnt(10)
    v_mfma_f32_32x32x16_bf16 v[48:63], a[48:51], v[180:183], v[48:63]
    ds_read_b64_tr_b16 a[76:77], v34 offset:8192
    ds_read_b64_tr_b16 a[78:79], v34 offset:9216
    v_mfma_f32_32x32x16_bf16 v[64:79], a[52:55], v[180:183], v[64:79]
    ds_read_b64_tr_b16 a[80:81], v31 offset:12288
    ds_read_b64_tr_b16 a[82:83], v31 offset:13312
    s_waitcnt lgkmcnt(10)
    v_mfma_f32_32x32x16_bf16 v[80:95], a[56:59], v[180:183], v[80:95]
    ds_read_b64_tr_b16 a[84:85], v32 offset:12288
    ds_read_b64_tr_b16 a[86:87], v32 offset:13312
    v_mfma_f32_32x32x16_bf16 v[96:111], a[60:63], v[180:183], v[96:111]
    ds_read_b64_tr_b16 a[88:89], v33 offset:12288
    ds_read_b64_tr_b16 a[90:91], v33 offset:13312
    s_waitcnt lgkmcnt(10)
    v_mfma_f32_32x32x16_bf16 v[48:63], a[64:67], v[192:195], v[48:63]
    ds_read_b64_tr_b16 a[92:93], v34 offset:12288
    ds_read_b64_tr_b16 a[94:95], v34 offset:13312
    v_mfma_f32_32x32x16_bf16 v[64:79], a[68:71], v[192:195], v[64:79]
    v_add_u32 v248, 32768, v19
    v_add_u32 v249, 32768, v20
    v_add_u32 v250, 32768, v21
    v_add_u32 v251, 32768, v22
    ds_read_b64_tr_b16 a[32:33], v248 offset:0
    ds_read_b64_tr_b16 a[34:35], v248 offset:1024
    s_waitcnt lgkmcnt(10)
    v_mfma_f32_32x32x16_bf16 v[80:95], a[72:75], v[192:195], v[80:95]
    ds_read_b64_tr_b16 a[36:37], v249 offset:0
    ds_read_b64_tr_b16 a[38:39], v249 offset:1024
    v_mfma_f32_32x32x16_bf16 v[96:111], a[76:79], v[192:195], v[96:111]
    ds_read_b64_tr_b16 a[40:41], v250 offset:0
    ds_read_b64_tr_b16 a[42:43], v250 offset:1024
    s_waitcnt lgkmcnt(10)
    v_mfma_f32_32x32x16_bf16 v[48:63], a[80:83], v[196:199], v[48:63]
    ds_read_b64_tr_b16 a[44:45], v251 offset:0
    ds_read_b64_tr_b16 a[46:47], v251 offset:1024
    v_mfma_f32_32x32x16_bf16 v[64:79], a[84:87], v[196:199], v[64:79]
    ds_read_b64_tr_b16 a[48:49], v248 offset:4096
    ds_read_b64_tr_b16 a[50:51], v248 offset:5120
    s_waitcnt lgkmcnt(10)
    v_mfma_f32_32x32x16_bf16 v[80:95], a[88:91], v[196:199], v[80:95]
    ds_read_b64_tr_b16 a[52:53], v249 offset:4096
    ds_read_b64_tr_b16 a[54:55], v249 offset:5120
    v_mfma_f32_32x32x16_bf16 v[96:111], a[92:95], v[196:199], v[96:111]
    ds_read_b64_tr_b16 a[56:57], v250 offset:4096
    ds_read_b64_tr_b16 a[58:59], v250 offset:5120
    s_waitcnt lgkmcnt(10)
    v_mfma_f32_32x32x16_bf16 v[48:63], a[32:35], v[208:211], v[48:63]
    ds_read_b64_tr_b16 a[60:61], v251 offset:4096
    ds_read_b64_tr_b16 a[62:63], v251 offset:5120
    v_mfma_f32_32x32x16_bf16 v[64:79], a[36:39], v[208:211], v[64:79]
    ds_read_b64_tr_b16 a[64:65], v248 offset:8192
    ds_read_b64_tr_b16 a[66:67], v248 offset:9216
    s_waitcnt lgkmcnt(10)
    v_mfma_f32_32x32x16_bf16 v[80:95], a[40:43], v[208:211], v[80:95]
    ds_read_b64_tr_b16 a[68:69], v249 offset:8192
    ds_read_b64_tr_b16 a[70:71], v249 offset:9216
    v_mfma_f32_32x32x16_bf16 v[96:111], a[44:47], v[208:211], v[96:111]
    ds_read_b64_tr_b16 a[72:73], v250 offset:8192
    ds_read_b64_tr_b16 a[74:75], v250 offset:9216
    s_waitcnt lgkmcnt(10)
    v_mfma_f32_32x32x16_bf16 v[48:63], a[48:51], v[212:215], v[48:63]
    ds_read_b64_tr_b16 a[76:77], v251 offset:8192
    ds_read_b64_tr_b16 a[78:79], v251 offset:9216
    v_mfma_f32_32x32x16_bf16 v[64:79], a[52:55], v[212:215], v[64:79]
    ds_read_b64_tr_b16 a[80:81], v248 offset:12288
    ds_read_b64_tr_b16 a[82:83], v248 offset:13312
    s_waitcnt lgkmcnt(10)
    v_mfma_f32_32x32x16_bf16 v[80:95], a[56:59], v[212:215], v[80:95]
    ds_read_b64_tr_b16 a[84:85], v249 offset:12288
    ds_read_b64_tr_b16 a[86:87], v249 offset:13312
    v_mfma_f32_32x32x16_bf16 v[96:111], a[60:63], v[212:215], v[96:111]
    ds_read_b64_tr_b16 a[88:89], v250 offset:12288
    ds_read_b64_tr_b16 a[90:91], v250 offset:13312
    s_waitcnt lgkmcnt(10)
    v_mfma_f32_32x32x16_bf16 v[48:63], a[64:67], v[224:227], v[48:63]
    ds_read_b64_tr_b16 a[92:93], v251 offset:12288
    ds_read_b64_tr_b16 a[94:95], v251 offset:13312
    v_mfma_f32_32x32x16_bf16 v[64:79], a[68:71], v[224:227], v[64:79]
    s_waitcnt lgkmcnt(8)
    v_mfma_f32_32x32x16_bf16 v[80:95], a[72:75], v[224:227], v[80:95]
    v_mfma_f32_32x32x16_bf16 v[96:111], a[76:79], v[224:227], v[96:111]
    s_waitcnt lgkmcnt(4)
    v_mfma_f32_32x32x16_bf16 v[48:63], a[80:83], v[228:231], v[48:63]
    v_mfma_f32_32x32x16_bf16 v[64:79], a[84:87], v[228:231], v[64:79]
    s_waitcnt lgkmcnt(0)
    v_mfma_f32_32x32x16_bf16 v[80:95], a[88:91], v[228:231], v[80:95]
    v_mfma_f32_32x32x16_bf16 v[96:111], a[92:95], v[228:231], v[96:111]
    s_nop 11
    v_add_f32 v40, v40, v0
    v_mov_b32 v44, v40
    s_nop 1
    v_permlane32_swap_b32 v40, v44
    v_add_f32 v40, v40, v44
    v_rcp_f32 v42, v40
    s_nop 0
    v_mul_f32 v48, v48, v42
    v_mul_f32 v49, v49, v42
    v_mul_f32 v50, v50, v42
    v_mul_f32 v51, v51, v42
    v_mul_f32 v52, v52, v42
    v_mul_f32 v53, v53, v42
    v_mul_f32 v54, v54, v42
    v_mul_f32 v55, v55, v42
    v_cvt_pk_bf16_f32 v112, v48, v49
    v_cvt_pk_bf16_f32 v113, v50, v51
    v_cvt_pk_bf16_f32 v114, v52, v53
    v_cvt_pk_bf16_f32 v115, v54, v55
    buffer_store_dwordx4 v[112:115], v47, s[24:27], 0 offen offset:0
    v_mul_f32 v56, v56, v42
    v_mul_f32 v57, v57, v42
    v_mul_f32 v58, v58, v42
    v_mul_f32 v59, v59, v42
    v_mul_f32 v60, v60, v42
    v_mul_f32 v61, v61, v42
    v_mul_f32 v62, v62, v42
    v_mul_f32 v63, v63, v42
    v_cvt_pk_bf16_f32 v120, v56, v57
    v_cvt_pk_bf16_f32 v121, v58, v59
    v_cvt_pk_bf16_f32 v122, v60, v61
    v_cvt_pk_bf16_f32 v123, v62, v63
    buffer_store_dwordx4 v[120:123], v47, s[24:27], 0 offen offset:512
    v_mul_f32 v64, v64, v42
    v_mul_f32 v65, v65, v42
    v_mul_f32 v66, v66, v42
    v_mul_f32 v67, v67, v42
    v_mul_f32 v68, v68, v42
    v_mul_f32 v69, v69, v42
    v_mul_f32 v70, v70, v42
    v_mul_f32 v71, v71, v42
    v_cvt_pk_bf16_f32 v128, v64, v65
    v_cvt_pk_bf16_f32 v129, v66, v67
    v_cvt_pk_bf16_f32 v130, v68, v69
    v_cvt_pk_bf16_f32 v131, v70, v71
    buffer_store_dwordx4 v[128:131], v47, s[24:27], 0 offen offset:1024
    v_mul_f32 v72, v72, v42
    v_mul_f32 v73, v73, v42
    v_mul_f32 v74, v74, v42
    v_mul_f32 v75, v75, v42
    v_mul_f32 v76, v76, v42
    v_mul_f32 v77, v77, v42
    v_mul_f32 v78, v78, v42
    v_mul_f32 v79, v79, v42
    v_cvt_pk_bf16_f32 v136, v72, v73
    v_cvt_pk_bf16_f32 v137, v74, v75
    v_cvt_pk_bf16_f32 v138, v76, v77
    v_cvt_pk_bf16_f32 v139, v78, v79
    buffer_store_dwordx4 v[136:139], v47, s[24:27], 0 offen offset:1536
    v_mul_f32 v80, v80, v42
    v_mul_f32 v81, v81, v42
    v_mul_f32 v82, v82, v42
    v_mul_f32 v83, v83, v42
    v_mul_f32 v84, v84, v42
    v_mul_f32 v85, v85, v42
    v_mul_f32 v86, v86, v42
    v_mul_f32 v87, v87, v42
    v_cvt_pk_bf16_f32 v144, v80, v81
    v_cvt_pk_bf16_f32 v145, v82, v83
    v_cvt_pk_bf16_f32 v146, v84, v85
    v_cvt_pk_bf16_f32 v147, v86, v87
    buffer_store_dwordx4 v[144:147], v47, s[24:27], 0 offen offset:2048
    v_mul_f32 v88, v88, v42
    v_mul_f32 v89, v89, v42
    v_mul_f32 v90, v90, v42
    v_mul_f32 v91, v91, v42
    v_mul_f32 v92, v92, v42
    v_mul_f32 v93, v93, v42
    v_mul_f32 v94, v94, v42
    v_mul_f32 v95, v95, v42
    v_cvt_pk_bf16_f32 v152, v88, v89
    v_cvt_pk_bf16_f32 v153, v90, v91
    v_cvt_pk_bf16_f32 v154, v92, v93
    v_cvt_pk_bf16_f32 v155, v94, v95
    buffer_store_dwordx4 v[152:155], v47, s[24:27], 0 offen offset:2560
    v_mul_f32 v96, v96, v42
    v_mul_f32 v97, v97, v42
    v_mul_f32 v98, v98, v42
    v_mul_f32 v99, v99, v42
    v_mul_f32 v100, v100, v42
    v_mul_f32 v101, v101, v42
    v_mul_f32 v102, v102, v42
    v_mul_f32 v103, v103, v42
    v_cvt_pk_bf16_f32 v160, v96, v97
    v_cvt_pk_bf16_f32 v161, v98, v99
    v_cvt_pk_bf16_f32 v162, v100, v101
    v_cvt_pk_bf16_f32 v163, v102, v103
    buffer_store_dwordx4 v[160:163], v47, s[24:27], 0 offen offset:3072
    v_mul_f32 v104, v104, v42
    v_mul_f32 v105, v105, v42
    v_mul_f32 v106, v106, v42
    v_mul_f32 v107, v107, v42
    v_mul_f32 v108, v108, v42
    v_mul_f32 v109, v109, v42
    v_mul_f32 v110, v110, v42
    v_mul_f32 v111, v111, v42
    v_cvt_pk_bf16_f32 v168, v104, v105
    v_cvt_pk_bf16_f32 v169, v106, v107
    v_cvt_pk_bf16_f32 v170, v108, v109
    v_cvt_pk_bf16_f32 v171, v110, v111
    buffer_store_dwordx4 v[168:171], v47, s[24:27], 0 offen offset:3584
    s_waitcnt vmcnt(8)
    v_lshrrev_b32 v44, 4, v1
    v_and_b32 v45, 15, v1
    v_lshrrev_b32 v46, 2, v45
    v_lshl_add_u32 v44, v44, 3, v46
    s_movk_i32 s38, 160
    v_mul_lo_u32 v44, v44, s38
    v_and_b32 v45, 3, v45
    v_lshl_add_u32 v44, v45, 3, v44
    v_add_u32 v44, s53, v44
    s_lshl_b32 s36, s2, 2
    s_add_u32 s36, s36, s32
    s_and_b32 s37, s36, 7
    s_lshr_b32 s36, s36, 3
    s_mul_i32 s37, s37, 655360
    s_lshl_b32 s36, s36, 10
    s_add_u32 s36, s36, s37
    s_add_u32 s36, s36, 8388608
    v_lshlrev_b32 v45, 4, v1
    ds_read_b64_tr_b16 v[112:113], v44 offset:0
    ds_read_b64_tr_b16 v[114:115], v44 offset:640
    ds_read_b64_tr_b16 v[116:117], v44 offset:32
    ds_read_b64_tr_b16 v[118:119], v44 offset:672
    ds_read_b64_tr_b16 v[120:121], v44 offset:64
    ds_read_b64_tr_b16 v[122:123], v44 offset:704
    ds_read_b64_tr_b16 v[124:125], v44 offset:96
    ds_read_b64_tr_b16 v[126:127], v44 offset:736
    ds_read_b64_tr_b16 v[128:129], v44 offset:128
    ds_read_b64_tr_b16 v[130:131], v44 offset:768
    s_waitcnt lgkmcnt(0)
    s_add_u32 s37, s36, 0
    buffer_store_dwordx4 v[112:115], v45, s[24:27], s37 offen
    s_add_u32 s37, s36, 131072
    buffer_store_dwordx4 v[116:119], v45, s[24:27], s37 offen
    s_add_u32 s37, s36, 262144
    buffer_store_dwordx4 v[120:123], v45, s[24:27], s37 offen
    s_add_u32 s37, s36, 393216
    buffer_store_dwordx4 v[124:127], v45, s[24:27], s37 offen
    s_add_u32 s37, s36, 524288
    buffer_store_dwordx4 v[128:131], v45, s[24:27], s37 offen
k1_done:
    s_endpgm
.globl k2_kernel
.p2align 8
.type k2_kernel,@function
k2_kernel:
    s_cmp_ge_u32 s2, 256
    s_cbranch_scc1 k2_done
    s_load_dwordx2 s[4:5], s[0:1], 56
    s_load_dwordx4 s[44:47], s[0:1], 32
    s_load_dwordx2 s[48:49], s[0:1], 48
    v_and_b32 v3, 63, v0
    v_lshrrev_b32 v4, 6, v0
    s_nop 0
    v_readfirstlane_b32 s19, v4
    s_and_b32 s18, s2, 3
    s_lshr_b32 s20, s2, 2
    s_and_b32 s20, s20, 1
    s_lshl_b32 s20, s20, 2
    s_lshr_b32 s21, s2, 3
    s_and_b32 s16, s21, 3
    s_lshl_b32 s23, s16, 1
    s_add_u32 s16, s16, s20
    s_lshr_b32 s17, s2, 5
    s_add_u32 s23, s23, s17
    v_lshlrev_b32 v1, 4, v3
    s_waitcnt lgkmcnt(0)
    s_mov_b32 s8, s4
    s_and_b32 s9, s5, 0xffff
    s_mov_b32 s10, 16777216
    s_mov_b32 s11, 0x20000
    s_add_u32 s12, s4, 16777216
    s_addc_u32 s13, s5, 0
    s_and_b32 s13, s13, 0xffff
    s_mov_b32 s14, 9175040
    s_mov_b32 s15, 0x20000
    s_mov_b32 s40, s46
    s_and_b32 s41, s47, 0xffff
    s_mov_b32 s42, 1146880
    s_mov_b32 s43, 0x20000
    s_mov_b32 s52, s48
    s_and_b32 s53, s49, 0xffff
    s_mov_b32 s54, 256
    s_mov_b32 s55, 0x20000
    s_add_u32 s68, s4, 33554432
    s_addc_u32 s69, s5, 0
    s_and_b32 s69, s69, 0xffff
    s_mov_b32 s70, 65536
    s_mov_b32 s71, 0x20000
    s_lshl_b32 s20, s18, 5
    s_lshl_b32 s21, s19, 3
    s_add_u32 s20, s20, s21
    s_lshl_b32 s20, s20, 10
    s_mul_i32 s21, s17, 655360
    s_add_u32 s21, s21, s20
    s_add_u32 s21, s21, 8388608
    s_add_u32 s24, s21, 0
    s_add_u32 s25, s21, 131072
    s_add_u32 s26, s21, 262144
    s_add_u32 s27, s21, 393216
    s_add_u32 s28, s21, 524288
    s_mul_i32 s21, s16, 917504
    s_add_u32 s21, s21, s20
    s_add_u32 s32, s21, 0
    s_add_u32 s33, s21, 131072
    s_add_u32 s34, s21, 262144
    s_add_u32 s35, s21, 393216
    s_add_u32 s36, s21, 524288
    s_add_u32 s37, s21, 655360
    s_add_u32 s38, s21, 786432
    s_add_u32 s22, s23, 0
    s_and_b32 s22, s22, 7
    s_lshl_b32 s22, s22, 10
    v_add_u32 v2, s22, v1
    buffer_load_dwordx4 v[8:11], v2, s[8:11], s24 offen
    buffer_load_dwordx4 v[12:15], v2, s[8:11], s25 offen
    buffer_load_dwordx4 v[16:19], v2, s[8:11], s26 offen
    buffer_load_dwordx4 v[20:23], v2, s[8:11], s27 offen
    buffer_load_dwordx4 v[24:27], v2, s[8:11], s28 offen
    buffer_load_dwordx4 v[28:31], v2, s[8:11], s32 offen
    buffer_load_dwordx4 v[32:35], v2, s[8:11], s33 offen
    buffer_load_dwordx4 v[36:39], v2, s[8:11], s34 offen
    buffer_load_dwordx4 v[40:43], v2, s[8:11], s35 offen
    buffer_load_dwordx4 v[44:47], v2, s[8:11], s36 offen
    buffer_load_dwordx4 v[48:51], v2, s[8:11], s37 offen
    buffer_load_dwordx4 v[52:55], v2, s[8:11], s38 offen
    s_add_u32 s22, s23, 1
    s_and_b32 s22, s22, 7
    s_lshl_b32 s22, s22, 10
    v_add_u32 v2, s22, v1
    buffer_load_dwordx4 v[56:59], v2, s[8:11], s24 offen
    buffer_load_dwordx4 v[60:63], v2, s[8:11], s25 offen
    buffer_load_dwordx4 v[64:67], v2, s[8:11], s26 offen
    buffer_load_dwordx4 v[68:71], v2, s[8:11], s27 offen
    buffer_load_dwordx4 v[72:75], v2, s[8:11], s28 offen
    buffer_load_dwordx4 v[76:79], v2, s[8:11], s32 offen
    buffer_load_dwordx4 v[80:83], v2, s[8:11], s33 offen
    buffer_load_dwordx4 v[84:87], v2, s[8:11], s34 offen
    buffer_load_dwordx4 v[88:91], v2, s[8:11], s35 offen
    buffer_load_dwordx4 v[92:95], v2, s[8:11], s36 offen
    buffer_load_dwordx4 v[96:99], v2, s[8:11], s37 offen
    buffer_load_dwordx4 v[100:103], v2, s[8:11], s38 offen
    s_add_u32 s22, s23, 2
    s_and_b32 s22, s22, 7
    s_lshl_b32 s22, s22, 10
    v_add_u32 v2, s22, v1
    buffer_load_dwordx4 v[104:107], v2, s[8:11], s24 offen
    buffer_load_dwordx4 v[108:111], v2, s[8:11], s25 offen
    buffer_load_dwordx4 v[112:115], v2, s[8:11], s26 offen
    buffer_load_dwordx4 v[116:119], v2, s[8:11], s27 offen
    buffer_load_dwordx4 v[120:123], v2, s[8:11], s28 offen
    buffer_load_dwordx4 v[124:127], v2, s[8:11], s32 offen
    buffer_load_dwordx4 v[128:131], v2, s[8:11], s33 offen
    buffer_load_dwordx4 v[132:135], v2, s[8:11], s34 offen
    buffer_load_dwordx4 v[136:139], v2, s[8:11], s35 offen
    buffer_load_dwordx4 v[140:143], v2, s[8:11], s36 offen
    buffer_load_dwordx4 v[144:147], v2, s[8:11], s37 offen
    buffer_load_dwordx4 v[148:151], v2, s[8:11], s38 offen
    s_add_u32 s22, s23, 3
    s_and_b32 s22, s22, 7
    s_lshl_b32 s22, s22, 10
    v_add_u32 v2, s22, v1
    buffer_load_dwordx4 v[152:155], v2, s[8:11], s24 offen
    buffer_load_dwordx4 v[156:159], v2, s[8:11], s25 offen
    buffer_load_dwordx4 v[160:163], v2, s[8:11], s26 offen
    buffer_load_dwordx4 v[164:167], v2, s[8:11], s27 offen
    buffer_load_dwordx4 v[168:171], v2, s[8:11], s28 offen
    buffer_load_dwordx4 v[172:175], v2, s[8:11], s32 offen
    buffer_load_dwordx4 v[176:179], v2, s[8:11], s33 offen
    buffer_load_dwordx4 v[180:183], v2, s[8:11], s34 offen
    buffer_load_dwordx4 v[184:187], v2, s[8:11], s35 offen
    buffer_load_dwordx4 v[188:191], v2, s[8:11], s36 offen
    buffer_load_dwordx4 v[192:195], v2, s[8:11], s37 offen
    buffer_load_dwordx4 v[196:199], v2, s[8:11], s38 offen
    s_waitcnt vmcnt(36)
    v_mfma_f32_16x16x32_bf16 a[0:3], v[8:11], v[28:31], 0
    v_mfma_f32_16x16x32_bf16 a[4:7], v[8:11], v[32:35], 0
    v_mfma_f32_16x16x32_bf16 a[8:11], v[8:11], v[36:39], 0
    v_mfma_f32_16x16x32_bf16 a[12:15], v[8:11], v[40:43], 0
    v_mfma_f32_16x16x32_bf16 a[16:19], v[8:11], v[44:47], 0
    v_mfma_f32_16x16x32_bf16 a[20:23], v[8:11], v[48:51], 0
    v_mfma_f32_16x16x32_bf16 a[24:27], v[8:11], v[52:55], 0
    v_mfma_f32_16x16x32_bf16 a[28:31], v[12:15], v[28:31], 0
    v_mfma_f32_16x16x32_bf16 a[32:35], v[12:15], v[32:35], 0
    v_mfma_f32_16x16x32_bf16 a[36:39], v[12:15], v[36:39], 0
    v_mfma_f32_16x16x32_bf16 a[40:43], v[12:15], v[40:43], 0
    v_mfma_f32_16x16x32_bf16 a[44:47], v[12:15], v[44:47], 0
    v_mfma_f32_16x16x32_bf16 a[48:51], v[12:15], v[48:51], 0
    v_mfma_f32_16x16x32_bf16 a[52:55], v[12:15], v[52:55], 0
    v_mfma_f32_16x16x32_bf16 a[56:59], v[16:19], v[28:31], 0
    v_mfma_f32_16x16x32_bf16 a[60:63], v[16:19], v[32:35], 0
    v_mfma_f32_16x16x32_bf16 a[64:67], v[16:19], v[36:39], 0
    v_mfma_f32_16x16x32_bf16 a[68:71], v[16:19], v[40:43], 0
    v_mfma_f32_16x16x32_bf16 a[72:75], v[16:19], v[44:47], 0
    v_mfma_f32_16x16x32_bf16 a[76:79], v[16:19], v[48:51], 0
    v_mfma_f32_16x16x32_bf16 a[80:83], v[16:19], v[52:55], 0
    v_mfma_f32_16x16x32_bf16 a[84:87], v[20:23], v[28:31], 0
    v_mfma_f32_16x16x32_bf16 a[88:91], v[20:23], v[32:35], 0
    v_mfma_f32_16x16x32_bf16 a[92:95], v[20:23], v[36:39], 0
    v_mfma_f32_16x16x32_bf16 a[96:99], v[20:23], v[40:43], 0
    v_mfma_f32_16x16x32_bf16 a[100:103], v[20:23], v[44:47], 0
    v_mfma_f32_16x16x32_bf16 a[104:107], v[20:23], v[48:51], 0
    v_mfma_f32_16x16x32_bf16 a[108:111], v[20:23], v[52:55], 0
    v_mfma_f32_16x16x32_bf16 a[112:115], v[24:27], v[28:31], 0
    v_mfma_f32_16x16x32_bf16 a[116:119], v[24:27], v[32:35], 0
    v_mfma_f32_16x16x32_bf16 a[120:123], v[24:27], v[36:39], 0
    v_mfma_f32_16x16x32_bf16 a[124:127], v[24:27], v[40:43], 0
    v_mfma_f32_16x16x32_bf16 a[128:131], v[24:27], v[44:47], 0
    v_mfma_f32_16x16x32_bf16 a[132:135], v[24:27], v[48:51], 0
    v_mfma_f32_16x16x32_bf16 a[136:139], v[24:27], v[52:55], 0
    s_add_u32 s22, s23, 4
    s_and_b32 s22, s22, 7
    s_lshl_b32 s22, s22, 10
    v_add_u32 v2, s22, v1
    buffer_load_dwordx4 v[8:11], v2, s[8:11], s24 offen
    buffer_load_dwordx4 v[12:15], v2, s[8:11], s25 offen
    buffer_load_dwordx4 v[16:19], v2, s[8:11], s26 offen
    buffer_load_dwordx4 v[20:23], v2, s[8:11], s27 offen
    buffer_load_dwordx4 v[24:27], v2, s[8:11], s28 offen
    buffer_load_dwordx4 v[28:31], v2, s[8:11], s32 offen
    buffer_load_dwordx4 v[32:35], v2, s[8:11], s33 offen
    buffer_load_dwordx4 v[36:39], v2, s[8:11], s34 offen
    buffer_load_dwordx4 v[40:43], v2, s[8:11], s35 offen
    buffer_load_dwordx4 v[44:47], v2, s[8:11], s36 offen
    buffer_load_dwordx4 v[48:51], v2, s[8:11], s37 offen
    buffer_load_dwordx4 v[52:55], v2, s[8:11], s38 offen
    s_waitcnt vmcnt(36)
    v_mfma_f32_16x16x32_bf16 a[0:3], v[56:59], v[76:79], a[0:3]
    v_mfma_f32_16x16x32_bf16 a[4:7], v[56:59], v[80:83], a[4:7]
    v_mfma_f32_16x16x32_bf16 a[8:11], v[56:59], v[84:87], a[8:11]
    v_mfma_f32_16x16x32_bf16 a[12:15], v[56:59], v[88:91], a[12:15]
    v_mfma_f32_16x16x32_bf16 a[16:19], v[56:59], v[92:95], a[16:19]
    v_mfma_f32_16x16x32_bf16 a[20:23], v[56:59], v[96:99], a[20:23]
    v_mfma_f32_16x16x32_bf16 a[24:27], v[56:59], v[100:103], a[24:27]
    v_mfma_f32_16x16x32_bf16 a[28:31], v[60:63], v[76:79], a[28:31]
    v_mfma_f32_16x16x32_bf16 a[32:35], v[60:63], v[80:83], a[32:35]
    v_mfma_f32_16x16x32_bf16 a[36:39], v[60:63], v[84:87], a[36:39]
    v_mfma_f32_16x16x32_bf16 a[40:43], v[60:63], v[88:91], a[40:43]
    v_mfma_f32_16x16x32_bf16 a[44:47], v[60:63], v[92:95], a[44:47]
    v_mfma_f32_16x16x32_bf16 a[48:51], v[60:63], v[96:99], a[48:51]
    v_mfma_f32_16x16x32_bf16 a[52:55], v[60:63], v[100:103], a[52:55]
    v_mfma_f32_16x16x32_bf16 a[56:59], v[64:67], v[76:79], a[56:59]
    v_mfma_f32_16x16x32_bf16 a[60:63], v[64:67], v[80:83], a[60:63]
    v_mfma_f32_16x16x32_bf16 a[64:67], v[64:67], v[84:87], a[64:67]
    v_mfma_f32_16x16x32_bf16 a[68:71], v[64:67], v[88:91], a[68:71]
    v_mfma_f32_16x16x32_bf16 a[72:75], v[64:67], v[92:95], a[72:75]
    v_mfma_f32_16x16x32_bf16 a[76:79], v[64:67], v[96:99], a[76:79]
    v_mfma_f32_16x16x32_bf16 a[80:83], v[64:67], v[100:103], a[80:83]
    v_mfma_f32_16x16x32_bf16 a[84:87], v[68:71], v[76:79], a[84:87]
    v_mfma_f32_16x16x32_bf16 a[88:91], v[68:71], v[80:83], a[88:91]
    v_mfma_f32_16x16x32_bf16 a[92:95], v[68:71], v[84:87], a[92:95]
    v_mfma_f32_16x16x32_bf16 a[96:99], v[68:71], v[88:91], a[96:99]
    v_mfma_f32_16x16x32_bf16 a[100:103], v[68:71], v[92:95], a[100:103]
    v_mfma_f32_16x16x32_bf16 a[104:107], v[68:71], v[96:99], a[104:107]
    v_mfma_f32_16x16x32_bf16 a[108:111], v[68:71], v[100:103], a[108:111]
    v_mfma_f32_16x16x32_bf16 a[112:115], v[72:75], v[76:79], a[112:115]
    v_mfma_f32_16x16x32_bf16 a[116:119], v[72:75], v[80:83], a[116:119]
    v_mfma_f32_16x16x32_bf16 a[120:123], v[72:75], v[84:87], a[120:123]
    v_mfma_f32_16x16x32_bf16 a[124:127], v[72:75], v[88:91], a[124:127]
    v_mfma_f32_16x16x32_bf16 a[128:131], v[72:75], v[92:95], a[128:131]
    v_mfma_f32_16x16x32_bf16 a[132:135], v[72:75], v[96:99], a[132:135]
    v_mfma_f32_16x16x32_bf16 a[136:139], v[72:75], v[100:103], a[136:139]
    s_add_u32 s22, s23, 5
    s_and_b32 s22, s22, 7
    s_lshl_b32 s22, s22, 10
    v_add_u32 v2, s22, v1
    buffer_load_dwordx4 v[56:59], v2, s[8:11], s24 offen
    buffer_load_dwordx4 v[60:63], v2, s[8:11], s25 offen
    buffer_load_dwordx4 v[64:67], v2, s[8:11], s26 offen
    buffer_load_dwordx4 v[68:71], v2, s[8:11], s27 offen
    buffer_load_dwordx4 v[72:75], v2, s[8:11], s28 offen
    buffer_load_dwordx4 v[76:79], v2, s[8:11], s32 offen
    buffer_load_dwordx4 v[80:83], v2, s[8:11], s33 offen
    buffer_load_dwordx4 v[84:87], v2, s[8:11], s34 offen
    buffer_load_dwordx4 v[88:91], v2, s[8:11], s35 offen
    buffer_load_dwordx4 v[92:95], v2, s[8:11], s36 offen
    buffer_load_dwordx4 v[96:99], v2, s[8:11], s37 offen
    buffer_load_dwordx4 v[100:103], v2, s[8:11], s38 offen
    s_waitcnt vmcnt(36)
    v_mfma_f32_16x16x32_bf16 a[0:3], v[104:107], v[124:127], a[0:3]
    v_mfma_f32_16x16x32_bf16 a[4:7], v[104:107], v[128:131], a[4:7]
    v_mfma_f32_16x16x32_bf16 a[8:11], v[104:107], v[132:135], a[8:11]
    v_mfma_f32_16x16x32_bf16 a[12:15], v[104:107], v[136:139], a[12:15]
    v_mfma_f32_16x16x32_bf16 a[16:19], v[104:107], v[140:143], a[16:19]
    v_mfma_f32_16x16x32_bf16 a[20:23], v[104:107], v[144:147], a[20:23]
    v_mfma_f32_16x16x32_bf16 a[24:27], v[104:107], v[148:151], a[24:27]
    v_mfma_f32_16x16x32_bf16 a[28:31], v[108:111], v[124:127], a[28:31]
    v_mfma_f32_16x16x32_bf16 a[32:35], v[108:111], v[128:131], a[32:35]
    v_mfma_f32_16x16x32_bf16 a[36:39], v[108:111], v[132:135], a[36:39]
    v_mfma_f32_16x16x32_bf16 a[40:43], v[108:111], v[136:139], a[40:43]
    v_mfma_f32_16x16x32_bf16 a[44:47], v[108:111], v[140:143], a[44:47]
    v_mfma_f32_16x16x32_bf16 a[48:51], v[108:111], v[144:147], a[48:51]
    v_mfma_f32_16x16x32_bf16 a[52:55], v[108:111], v[148:151], a[52:55]
    v_mfma_f32_16x16x32_bf16 a[56:59], v[112:115], v[124:127], a[56:59]
    v_mfma_f32_16x16x32_bf16 a[60:63], v[112:115], v[128:131], a[60:63]
    v_mfma_f32_16x16x32_bf16 a[64:67], v[112:115], v[132:135], a[64:67]
    v_mfma_f32_16x16x32_bf16 a[68:71], v[112:115], v[136:139], a[68:71]
    v_mfma_f32_16x16x32_bf16 a[72:75], v[112:115], v[140:143], a[72:75]
    v_mfma_f32_16x16x32_bf16 a[76:79], v[112:115], v[144:147], a[76:79]
    v_mfma_f32_16x16x32_bf16 a[80:83], v[112:115], v[148:151], a[80:83]
    v_mfma_f32_16x16x32_bf16 a[84:87], v[116:119], v[124:127], a[84:87]
    v_mfma_f32_16x16x32_bf16 a[88:91], v[116:119], v[128:131], a[88:91]
    v_mfma_f32_16x16x32_bf16 a[92:95], v[116:119], v[132:135], a[92:95]
    v_mfma_f32_16x16x32_bf16 a[96:99], v[116:119], v[136:139], a[96:99]
    v_mfma_f32_16x16x32_bf16 a[100:103], v[116:119], v[140:143], a[100:103]
    v_mfma_f32_16x16x32_bf16 a[104:107], v[116:119], v[144:147], a[104:107]
    v_mfma_f32_16x16x32_bf16 a[108:111], v[116:119], v[148:151], a[108:111]
    v_mfma_f32_16x16x32_bf16 a[112:115], v[120:123], v[124:127], a[112:115]
    v_mfma_f32_16x16x32_bf16 a[116:119], v[120:123], v[128:131], a[116:119]
    v_mfma_f32_16x16x32_bf16 a[120:123], v[120:123], v[132:135], a[120:123]
    v_mfma_f32_16x16x32_bf16 a[124:127], v[120:123], v[136:139], a[124:127]
    v_mfma_f32_16x16x32_bf16 a[128:131], v[120:123], v[140:143], a[128:131]
    v_mfma_f32_16x16x32_bf16 a[132:135], v[120:123], v[144:147], a[132:135]
    v_mfma_f32_16x16x32_bf16 a[136:139], v[120:123], v[148:151], a[136:139]
    s_add_u32 s22, s23, 6
    s_and_b32 s22, s22, 7
    s_lshl_b32 s22, s22, 10
    v_add_u32 v2, s22, v1
    buffer_load_dwordx4 v[104:107], v2, s[8:11], s24 offen
    buffer_load_dwordx4 v[108:111], v2, s[8:11], s25 offen
    buffer_load_dwordx4 v[112:115], v2, s[8:11], s26 offen
    buffer_load_dwordx4 v[116:119], v2, s[8:11], s27 offen
    buffer_load_dwordx4 v[120:123], v2, s[8:11], s28 offen
    buffer_load_dwordx4 v[124:127], v2, s[8:11], s32 offen
    buffer_load_dwordx4 v[128:131], v2, s[8:11], s33 offen
    buffer_load_dwordx4 v[132:135], v2, s[8:11], s34 offen
    buffer_load_dwordx4 v[136:139], v2, s[8:11], s35 offen
    buffer_load_dwordx4 v[140:143], v2, s[8:11], s36 offen
    buffer_load_dwordx4 v[144:147], v2, s[8:11], s37 offen
    buffer_load_dwordx4 v[148:151], v2, s[8:11], s38 offen
    s_waitcnt vmcnt(36)
    v_mfma_f32_16x16x32_bf16 a[0:3], v[152:155], v[172:175], a[0:3]
    v_mfma_f32_16x16x32_bf16 a[4:7], v[152:155], v[176:179], a[4:7]
    v_mfma_f32_16x16x32_bf16 a[8:11], v[152:155], v[180:183], a[8:11]
    v_mfma_f32_16x16x32_bf16 a[12:15], v[152:155], v[184:187], a[12:15]
    v_mfma_f32_16x16x32_bf16 a[16:19], v[152:155], v[188:191], a[16:19]
    v_mfma_f32_16x16x32_bf16 a[20:23], v[152:155], v[192:195], a[20:23]
    v_mfma_f32_16x16x32_bf16 a[24:27], v[152:155], v[196:199], a[24:27]
    v_mfma_f32_16x16x32_bf16 a[28:31], v[156:159], v[172:175], a[28:31]
    v_mfma_f32_16x16x32_bf16 a[32:35], v[156:159], v[176:179], a[32:35]
    v_mfma_f32_16x16x32_bf16 a[36:39], v[156:159], v[180:183], a[36:39]
    v_mfma_f32_16x16x32_bf16 a[40:43], v[156:159], v[184:187], a[40:43]
    v_mfma_f32_16x16x32_bf16 a[44:47], v[156:159], v[188:191], a[44:47]
    v_mfma_f32_16x16x32_bf16 a[48:51], v[156:159], v[192:195], a[48:51]
    v_mfma_f32_16x16x32_bf16 a[52:55], v[156:159], v[196:199], a[52:55]
    v_mfma_f32_16x16x32_bf16 a[56:59], v[160:163], v[172:175], a[56:59]
    v_mfma_f32_16x16x32_bf16 a[60:63], v[160:163], v[176:179], a[60:63]
    v_mfma_f32_16x16x32_bf16 a[64:67], v[160:163], v[180:183], a[64:67]
    v_mfma_f32_16x16x32_bf16 a[68:71], v[160:163], v[184:187], a[68:71]
    v_mfma_f32_16x16x32_bf16 a[72:75], v[160:163], v[188:191], a[72:75]
    v_mfma_f32_16x16x32_bf16 a[76:79], v[160:163], v[192:195], a[76:79]
    v_mfma_f32_16x16x32_bf16 a[80:83], v[160:163], v[196:199], a[80:83]
    v_mfma_f32_16x16x32_bf16 a[84:87], v[164:167], v[172:175], a[84:87]
    v_mfma_f32_16x16x32_bf16 a[88:91], v[164:167], v[176:179], a[88:91]
    v_mfma_f32_16x16x32_bf16 a[92:95], v[164:167], v[180:183], a[92:95]
    v_mfma_f32_16x16x32_bf16 a[96:99], v[164:167], v[184:187], a[96:99]
    v_mfma_f32_16x16x32_bf16 a[100:103], v[164:167], v[188:191], a[100:103]
    v_mfma_f32_16x16x32_bf16 a[104:107], v[164:167], v[192:195], a[104:107]
    v_mfma_f32_16x16x32_bf16 a[108:111], v[164:167], v[196:199], a[108:111]
    v_mfma_f32_16x16x32_bf16 a[112:115], v[168:171], v[172:175], a[112:115]
    v_mfma_f32_16x16x32_bf16 a[116:119], v[168:171], v[176:179], a[116:119]
    v_mfma_f32_16x16x32_bf16 a[120:123], v[168:171], v[180:183], a[120:123]
    v_mfma_f32_16x16x32_bf16 a[124:127], v[168:171], v[184:187], a[124:127]
    v_mfma_f32_16x16x32_bf16 a[128:131], v[168:171], v[188:191], a[128:131]
    v_mfma_f32_16x16x32_bf16 a[132:135], v[168:171], v[192:195], a[132:135]
    v_mfma_f32_16x16x32_bf16 a[136:139], v[168:171], v[196:199], a[136:139]
    s_add_u32 s22, s23, 7
    s_and_b32 s22, s22, 7
    s_lshl_b32 s22, s22, 10
    v_add_u32 v2, s22, v1
    buffer_load_dwordx4 v[152:155], v2, s[8:11], s24 offen
    buffer_load_dwordx4 v[156:159], v2, s[8:11], s25 offen
    buffer_load_dwordx4 v[160:163], v2, s[8:11], s26 offen
    buffer_load_dwordx4 v[164:167], v2, s[8:11], s27 offen
    buffer_load_dwordx4 v[168:171], v2, s[8:11], s28 offen
    buffer_load_dwordx4 v[172:175], v2, s[8:11], s32 offen
    buffer_load_dwordx4 v[176:179], v2, s[8:11], s33 offen
    buffer_load_dwordx4 v[180:183], v2, s[8:11], s34 offen
    buffer_load_dwordx4 v[184:187], v2, s[8:11], s35 offen
    buffer_load_dwordx4 v[188:191], v2, s[8:11], s36 offen
    buffer_load_dwordx4 v[192:195], v2, s[8:11], s37 offen
    buffer_load_dwordx4 v[196:199], v2, s[8:11], s38 offen
    s_waitcnt vmcnt(36)
    v_mfma_f32_16x16x32_bf16 a[0:3], v[8:11], v[28:31], a[0:3]
    v_mfma_f32_16x16x32_bf16 a[4:7], v[8:11], v[32:35], a[4:7]
    v_mfma_f32_16x16x32_bf16 a[8:11], v[8:11], v[36:39], a[8:11]
    v_mfma_f32_16x16x32_bf16 a[12:15], v[8:11], v[40:43], a[12:15]
    v_mfma_f32_16x16x32_bf16 a[16:19], v[8:11], v[44:47], a[16:19]
    v_mfma_f32_16x16x32_bf16 a[20:23], v[8:11], v[48:51], a[20:23]
    v_mfma_f32_16x16x32_bf16 a[24:27], v[8:11], v[52:55], a[24:27]
    v_mfma_f32_16x16x32_bf16 a[28:31], v[12:15], v[28:31], a[28:31]
    v_mfma_f32_16x16x32_bf16 a[32:35], v[12:15], v[32:35], a[32:35]
    v_mfma_f32_16x16x32_bf16 a[36:39], v[12:15], v[36:39], a[36:39]
    v_mfma_f32_16x16x32_bf16 a[40:43], v[12:15], v[40:43], a[40:43]
    v_mfma_f32_16x16x32_bf16 a[44:47], v[12:15], v[44:47], a[44:47]
    v_mfma_f32_16x16x32_bf16 a[48:51], v[12:15], v[48:51], a[48:51]
    v_mfma_f32_16x16x32_bf16 a[52:55], v[12:15], v[52:55], a[52:55]
    v_mfma_f32_16x16x32_bf16 a[56:59], v[16:19], v[28:31], a[56:59]
    v_mfma_f32_16x16x32_bf16 a[60:63], v[16:19], v[32:35], a[60:63]
    v_mfma_f32_16x16x32_bf16 a[64:67], v[16:19], v[36:39], a[64:67]
    v_mfma_f32_16x16x32_bf16 a[68:71], v[16:19], v[40:43], a[68:71]
    v_mfma_f32_16x16x32_bf16 a[72:75], v[16:19], v[44:47], a[72:75]
    v_mfma_f32_16x16x32_bf16 a[76:79], v[16:19], v[48:51], a[76:79]
    v_mfma_f32_16x16x32_bf16 a[80:83], v[16:19], v[52:55], a[80:83]
    v_mfma_f32_16x16x32_bf16 a[84:87], v[20:23], v[28:31], a[84:87]
    v_mfma_f32_16x16x32_bf16 a[88:91], v[20:23], v[32:35], a[88:91]
    v_mfma_f32_16x16x32_bf16 a[92:95], v[20:23], v[36:39], a[92:95]
    v_mfma_f32_16x16x32_bf16 a[96:99], v[20:23], v[40:43], a[96:99]
    v_mfma_f32_16x16x32_bf16 a[100:103], v[20:23], v[44:47], a[100:103]
    v_mfma_f32_16x16x32_bf16 a[104:107], v[20:23], v[48:51], a[104:107]
    v_mfma_f32_16x16x32_bf16 a[108:111], v[20:23], v[52:55], a[108:111]
    v_mfma_f32_16x16x32_bf16 a[112:115], v[24:27], v[28:31], a[112:115]
    v_mfma_f32_16x16x32_bf16 a[116:119], v[24:27], v[32:35], a[116:119]
    v_mfma_f32_16x16x32_bf16 a[120:123], v[24:27], v[36:39], a[120:123]
    v_mfma_f32_16x16x32_bf16 a[124:127], v[24:27], v[40:43], a[124:127]
    v_mfma_f32_16x16x32_bf16 a[128:131], v[24:27], v[44:47], a[128:131]
    v_mfma_f32_16x16x32_bf16 a[132:135], v[24:27], v[48:51], a[132:135]
    v_mfma_f32_16x16x32_bf16 a[136:139], v[24:27], v[52:55], a[136:139]
    s_waitcnt vmcnt(24)
    v_mfma_f32_16x16x32_bf16 a[0:3], v[56:59], v[76:79], a[0:3]
    v_mfma_f32_16x16x32_bf16 a[4:7], v[56:59], v[80:83], a[4:7]
    v_mfma_f32_16x16x32_bf16 a[8:11], v[56:59], v[84:87], a[8:11]
    v_mfma_f32_16x16x32_bf16 a[12:15], v[56:59], v[88:91], a[12:15]
    v_mfma_f32_16x16x32_bf16 a[16:19], v[56:59], v[92:95], a[16:19]
    v_mfma_f32_16x16x32_bf16 a[20:23], v[56:59], v[96:99], a[20:23]
    v_mfma_f32_16x16x32_bf16 a[24:27], v[56:59], v[100:103], a[24:27]
    v_mfma_f32_16x16x32_bf16 a[28:31], v[60:63], v[76:79], a[28:31]
    v_mfma_f32_16x16x32_bf16 a[32:35], v[60:63], v[80:83], a[32:35]
    v_mfma_f32_16x16x32_bf16 a[36:39], v[60:63], v[84:87], a[36:39]
    v_mfma_f32_16x16x32_bf16 a[40:43], v[60:63], v[88:91], a[40:43]
    v_mfma_f32_16x16x32_bf16 a[44:47], v[60:63], v[92:95], a[44:47]
    v_mfma_f32_16x16x32_bf16 a[48:51], v[60:63], v[96:99], a[48:51]
    v_mfma_f32_16x16x32_bf16 a[52:55], v[60:63], v[100:103], a[52:55]
    v_mfma_f32_16x16x32_bf16 a[56:59], v[64:67], v[76:79], a[56:59]
    v_mfma_f32_16x16x32_bf16 a[60:63], v[64:67], v[80:83], a[60:63]
    v_mfma_f32_16x16x32_bf16 a[64:67], v[64:67], v[84:87], a[64:67]
    v_mfma_f32_16x16x32_bf16 a[68:71], v[64:67], v[88:91], a[68:71]
    v_mfma_f32_16x16x32_bf16 a[72:75], v[64:67], v[92:95], a[72:75]
    v_mfma_f32_16x16x32_bf16 a[76:79], v[64:67], v[96:99], a[76:79]
    v_mfma_f32_16x16x32_bf16 a[80:83], v[64:67], v[100:103], a[80:83]
    v_mfma_f32_16x16x32_bf16 a[84:87], v[68:71], v[76:79], a[84:87]
    v_mfma_f32_16x16x32_bf16 a[88:91], v[68:71], v[80:83], a[88:91]
    v_mfma_f32_16x16x32_bf16 a[92:95], v[68:71], v[84:87], a[92:95]
    v_mfma_f32_16x16x32_bf16 a[96:99], v[68:71], v[88:91], a[96:99]
    v_mfma_f32_16x16x32_bf16 a[100:103], v[68:71], v[92:95], a[100:103]
    v_mfma_f32_16x16x32_bf16 a[104:107], v[68:71], v[96:99], a[104:107]
    v_mfma_f32_16x16x32_bf16 a[108:111], v[68:71], v[100:103], a[108:111]
    v_mfma_f32_16x16x32_bf16 a[112:115], v[72:75], v[76:79], a[112:115]
    v_mfma_f32_16x16x32_bf16 a[116:119], v[72:75], v[80:83], a[116:119]
    v_mfma_f32_16x16x32_bf16 a[120:123], v[72:75], v[84:87], a[120:123]
    v_mfma_f32_16x16x32_bf16 a[124:127], v[72:75], v[88:91], a[124:127]
    v_mfma_f32_16x16x32_bf16 a[128:131], v[72:75], v[92:95], a[128:131]
    v_mfma_f32_16x16x32_bf16 a[132:135], v[72:75], v[96:99], a[132:135]
    v_mfma_f32_16x16x32_bf16 a[136:139], v[72:75], v[100:103], a[136:139]
    s_waitcnt vmcnt(12)
    v_mfma_f32_16x16x32_bf16 a[0:3], v[104:107], v[124:127], a[0:3]
    v_mfma_f32_16x16x32_bf16 a[4:7], v[104:107], v[128:131], a[4:7]
    v_mfma_f32_16x16x32_bf16 a[8:11], v[104:107], v[132:135], a[8:11]
    v_mfma_f32_16x16x32_bf16 a[12:15], v[104:107], v[136:139], a[12:15]
    v_mfma_f32_16x16x32_bf16 a[16:19], v[104:107], v[140:143], a[16:19]
    v_mfma_f32_16x16x32_bf16 a[20:23], v[104:107], v[144:147], a[20:23]
    v_mfma_f32_16x16x32_bf16 a[24:27], v[104:107], v[148:151], a[24:27]
    v_mfma_f32_16x16x32_bf16 a[28:31], v[108:111], v[124:127], a[28:31]
    v_mfma_f32_16x16x32_bf16 a[32:35], v[108:111], v[128:131], a[32:35]
    v_mfma_f32_16x16x32_bf16 a[36:39], v[108:111], v[132:135], a[36:39]
    v_mfma_f32_16x16x32_bf16 a[40:43], v[108:111], v[136:139], a[40:43]
    v_mfma_f32_16x16x32_bf16 a[44:47], v[108:111], v[140:143], a[44:47]
    v_mfma_f32_16x16x32_bf16 a[48:51], v[108:111], v[144:147], a[48:51]
    v_mfma_f32_16x16x32_bf16 a[52:55], v[108:111], v[148:151], a[52:55]
    v_mfma_f32_16x16x32_bf16 a[56:59], v[112:115], v[124:127], a[56:59]
    v_mfma_f32_16x16x32_bf16 a[60:63], v[112:115], v[128:131], a[60:63]
    v_mfma_f32_16x16x32_bf16 a[64:67], v[112:115], v[132:135], a[64:67]
    v_mfma_f32_16x16x32_bf16 a[68:71], v[112:115], v[136:139], a[68:71]
    v_mfma_f32_16x16x32_bf16 a[72:75], v[112:115], v[140:143], a[72:75]
    v_mfma_f32_16x16x32_bf16 a[76:79], v[112:115], v[144:147], a[76:79]
    v_mfma_f32_16x16x32_bf16 a[80:83], v[112:115], v[148:151], a[80:83]
    v_mfma_f32_16x16x32_bf16 a[84:87], v[116:119], v[124:127], a[84:87]
    v_mfma_f32_16x16x32_bf16 a[88:91], v[116:119], v[128:131], a[88:91]
    v_mfma_f32_16x16x32_bf16 a[92:95], v[116:119], v[132:135], a[92:95]
    v_mfma_f32_16x16x32_bf16 a[96:99], v[116:119], v[136:139], a[96:99]
    v_mfma_f32_16x16x32_bf16 a[100:103], v[116:119], v[140:143], a[100:103]
    v_mfma_f32_16x16x32_bf16 a[104:107], v[116:119], v[144:147], a[104:107]
    v_mfma_f32_16x16x32_bf16 a[108:111], v[116:119], v[148:151], a[108:111]
    v_mfma_f32_16x16x32_bf16 a[112:115], v[120:123], v[124:127], a[112:115]
    v_mfma_f32_16x16x32_bf16 a[116:119], v[120:123], v[128:131], a[116:119]
    v_mfma_f32_16x16x32_bf16 a[120:123], v[120:123], v[132:135], a[120:123]
    v_mfma_f32_16x16x32_bf16 a[124:127], v[120:123], v[136:139], a[124:127]
    v_mfma_f32_16x16x32_bf16 a[128:131], v[120:123], v[140:143], a[128:131]
    v_mfma_f32_16x16x32_bf16 a[132:135], v[120:123], v[144:147], a[132:135]
    v_mfma_f32_16x16x32_bf16 a[136:139], v[120:123], v[148:151], a[136:139]
    s_waitcnt vmcnt(0)
    v_mfma_f32_16x16x32_bf16 a[0:3], v[152:155], v[172:175], a[0:3]
    v_mfma_f32_16x16x32_bf16 a[4:7], v[152:155], v[176:179], a[4:7]
    v_mfma_f32_16x16x32_bf16 a[8:11], v[152:155], v[180:183], a[8:11]
    v_mfma_f32_16x16x32_bf16 a[12:15], v[152:155], v[184:187], a[12:15]
    v_mfma_f32_16x16x32_bf16 a[16:19], v[152:155], v[188:191], a[16:19]
    v_mfma_f32_16x16x32_bf16 a[20:23], v[152:155], v[192:195], a[20:23]
    v_mfma_f32_16x16x32_bf16 a[24:27], v[152:155], v[196:199], a[24:27]
    v_mfma_f32_16x16x32_bf16 a[28:31], v[156:159], v[172:175], a[28:31]
    v_mfma_f32_16x16x32_bf16 a[32:35], v[156:159], v[176:179], a[32:35]
    v_mfma_f32_16x16x32_bf16 a[36:39], v[156:159], v[180:183], a[36:39]
    v_mfma_f32_16x16x32_bf16 a[40:43], v[156:159], v[184:187], a[40:43]
    v_mfma_f32_16x16x32_bf16 a[44:47], v[156:159], v[188:191], a[44:47]
    v_mfma_f32_16x16x32_bf16 a[48:51], v[156:159], v[192:195], a[48:51]
    v_mfma_f32_16x16x32_bf16 a[52:55], v[156:159], v[196:199], a[52:55]
    v_mfma_f32_16x16x32_bf16 a[56:59], v[160:163], v[172:175], a[56:59]
    v_mfma_f32_16x16x32_bf16 a[60:63], v[160:163], v[176:179], a[60:63]
    v_mfma_f32_16x16x32_bf16 a[64:67], v[160:163], v[180:183], a[64:67]
    v_mfma_f32_16x16x32_bf16 a[68:71], v[160:163], v[184:187], a[68:71]
    v_mfma_f32_16x16x32_bf16 a[72:75], v[160:163], v[188:191], a[72:75]
    v_mfma_f32_16x16x32_bf16 a[76:79], v[160:163], v[192:195], a[76:79]
    v_mfma_f32_16x16x32_bf16 a[80:83], v[160:163], v[196:199], a[80:83]
    v_mfma_f32_16x16x32_bf16 a[84:87], v[164:167], v[172:175], a[84:87]
    v_mfma_f32_16x16x32_bf16 a[88:91], v[164:167], v[176:179], a[88:91]
    v_mfma_f32_16x16x32_bf16 a[92:95], v[164:167], v[180:183], a[92:95]
    v_mfma_f32_16x16x32_bf16 a[96:99], v[164:167], v[184:187], a[96:99]
    v_mfma_f32_16x16x32_bf16 a[100:103], v[164:167], v[188:191], a[100:103]
    v_mfma_f32_16x16x32_bf16 a[104:107], v[164:167], v[192:195], a[104:107]
    v_mfma_f32_16x16x32_bf16 a[108:111], v[164:167], v[196:199], a[108:111]
    v_mfma_f32_16x16x32_bf16 a[112:115], v[168:171], v[172:175], a[112:115]
    v_mfma_f32_16x16x32_bf16 a[116:119], v[168:171], v[176:179], a[116:119]
    v_mfma_f32_16x16x32_bf16 a[120:123], v[168:171], v[180:183], a[120:123]
    v_mfma_f32_16x16x32_bf16 a[124:127], v[168:171], v[184:187], a[124:127]
    v_mfma_f32_16x16x32_bf16 a[128:131], v[168:171], v[188:191], a[128:131]
    v_mfma_f32_16x16x32_bf16 a[132:135], v[168:171], v[192:195], a[132:135]
    v_mfma_f32_16x16x32_bf16 a[136:139], v[168:171], v[196:199], a[136:139]
    s_nop 9
    s_mul_i32 s20, s19, 35840
    v_add_u32 v4, s20, v1
    ds_write_b128 v4, a[0:3] offset:0
    ds_write_b128 v4, a[4:7] offset:1024
    ds_write_b128 v4, a[8:11] offset:2048
    ds_write_b128 v4, a[12:15] offset:3072
    ds_write_b128 v4, a[16:19] offset:4096
    ds_write_b128 v4, a[20:23] offset:5120
    ds_write_b128 v4, a[24:27] offset:6144
    ds_write_b128 v4, a[28:31] offset:7168
    ds_write_b128 v4, a[32:35] offset:8192
    ds_write_b128 v4, a[36:39] offset:9216
    ds_write_b128 v4, a[40:43] offset:10240
    ds_write_b128 v4, a[44:47] offset:11264
    ds_write_b128 v4, a[48:51] offset:12288
    ds_write_b128 v4, a[52:55] offset:13312
    ds_write_b128 v4, a[56:59] offset:14336
    ds_write_b128 v4, a[60:63] offset:15360
    ds_write_b128 v4, a[64:67] offset:16384
    ds_write_b128 v4, a[68:71] offset:17408
    ds_write_b128 v4, a[72:75] offset:18432
    ds_write_b128 v4, a[76:79] offset:19456
    ds_write_b128 v4, a[80:83] offset:20480
    ds_write_b128 v4, a[84:87] offset:21504
    ds_write_b128 v4, a[88:91] offset:22528
    ds_write_b128 v4, a[92:95] offset:23552
    ds_write_b128 v4, a[96:99] offset:24576
    ds_write_b128 v4, a[100:103] offset:25600
    ds_write_b128 v4, a[104:107] offset:26624
    ds_write_b128 v4, a[108:111] offset:27648
    ds_write_b128 v4, a[112:115] offset:28672
    ds_write_b128 v4, a[116:119] offset:29696
    ds_write_b128 v4, a[120:123] offset:30720
    ds_write_b128 v4, a[124:127] offset:31744
    ds_write_b128 v4, a[128:131] offset:32768
    ds_write_b128 v4, a[132:135] offset:33792
    ds_write_b128 v4, a[136:139] offset:34816
    s_waitcnt lgkmcnt(0)
    s_barrier
    s_lshl_b32 s56, s16, 3
    s_add_u32 s56, s56, s17
    s_lshl_b32 s21, s19, 10
    s_mul_i32 s20, s56, 35840
    s_add_u32 s20, s20, s21
    s_mov_b32 s57, s20
    s_mul_i32 s22, s18, 2293760
    s_add_u32 s20, s20, s22
    v_add_u32 v4, s21, v1
    v_add_u32 v5, 35840, v4
    v_add_u32 v6, 71680, v4
    v_add_u32 v7, 107520, v4
    ds_read_b128 v[64:67], v4 offset:0
    ds_read_b128 v[68:71], v5 offset:0
    ds_read_b128 v[72:75], v6 offset:0
    ds_read_b128 v[76:79], v7 offset:0
    ds_read_b128 v[80:83], v4 offset:4096
    ds_read_b128 v[84:87], v5 offset:4096
    ds_read_b128 v[88:91], v6 offset:4096
    ds_read_b128 v[92:95], v7 offset:4096
    ds_read_b128 v[96:99], v4 offset:8192
    ds_read_b128 v[100:103], v5 offset:8192
    ds_read_b128 v[104:107], v6 offset:8192
    ds_read_b128 v[108:111], v7 offset:8192
    ds_read_b128 v[112:115], v4 offset:12288
    ds_read_b128 v[116:119], v5 offset:12288
    ds_read_b128 v[120:123], v6 offset:12288
    ds_read_b128 v[124:127], v7 offset:12288
    ds_read_b128 v[128:131], v4 offset:16384
    ds_read_b128 v[132:135], v5 offset:16384
    ds_read_b128 v[136:139], v6 offset:16384
    ds_read_b128 v[140:143], v7 offset:16384
    ds_read_b128 v[144:147], v4 offset:20480
    ds_read_b128 v[148:151], v5 offset:20480
    ds_read_b128 v[152:155], v6 offset:20480
    ds_read_b128 v[156:159], v7 offset:20480
    ds_read_b128 v[160:163], v4 offset:24576
    ds_read_b128 v[164:167], v5 offset:24576
    ds_read_b128 v[168:171], v6 offset:24576
    ds_read_b128 v[172:175], v7 offset:24576
    ds_read_b128 v[176:179], v4 offset:28672
    ds_read_b128 v[180:183], v5 offset:28672
    ds_read_b128 v[184:187], v6 offset:28672
    ds_read_b128 v[188:191], v7 offset:28672
    ds_read_b128 v[192:195], v4 offset:32768
    ds_read_b128 v[196:199], v5 offset:32768
    ds_read_b128 v[200:203], v6 offset:32768
    ds_read_b128 v[204:207], v7 offset:32768
    s_waitcnt lgkmcnt(15)
    v_add_f32 v64, v64, v68
    v_add_f32 v72, v72, v76
    v_add_f32 v65, v65, v69
    v_add_f32 v73, v73, v77
    v_add_f32 v66, v66, v70
    v_add_f32 v74, v74, v78
    v_add_f32 v67, v67, v71
    v_add_f32 v75, v75, v79
    v_add_f32 v24, v64, v72
    v_add_f32 v25, v65, v73
    v_add_f32 v26, v66, v74
    v_add_f32 v27, v67, v75
    s_add_u32 s21, s20, 0
    buffer_store_dwordx4 v[24:27], v1, s[12:15], s21 offen sc0 sc1
    s_waitcnt lgkmcnt(15)
    v_add_f32 v80, v80, v84
    v_add_f32 v88, v88, v92
    v_add_f32 v81, v81, v85
    v_add_f32 v89, v89, v93
    v_add_f32 v82, v82, v86
    v_add_f32 v90, v90, v94
    v_add_f32 v83, v83, v87
    v_add_f32 v91, v91, v95
    v_add_f32 v28, v80, v88
    v_add_f32 v29, v81, v89
    v_add_f32 v30, v82, v90
    v_add_f32 v31, v83, v91
    s_add_u32 s21, s20, 4096
    buffer_store_dwordx4 v[28:31], v1, s[12:15], s21 offen sc0 sc1
    s_waitcnt lgkmcnt(15)
    v_add_f32 v96, v96, v100
    v_add_f32 v104, v104, v108
    v_add_f32 v97, v97, v101
    v_add_f32 v105, v105, v109
    v_add_f32 v98, v98, v102
    v_add_f32 v106, v106, v110
    v_add_f32 v99, v99, v103
    v_add_f32 v107, v107, v111
    v_add_f32 v32, v96, v104
    v_add_f32 v33, v97, v105
    v_add_f32 v34, v98, v106
    v_add_f32 v35, v99, v107
    s_add_u32 s21, s20, 8192
    buffer_store_dwordx4 v[32:35], v1, s[12:15], s21 offen sc0 sc1
    s_waitcnt lgkmcnt(15)
    v_add_f32 v112, v112, v116
    v_add_f32 v120, v120, v124
    v_add_f32 v113, v113, v117
    v_add_f32 v121, v121, v125
    v_add_f32 v114, v114, v118
    v_add_f32 v122, v122, v126
    v_add_f32 v115, v115, v119
    v_add_f32 v123, v123, v127
    v_add_f32 v36, v112, v120
    v_add_f32 v37, v113, v121
    v_add_f32 v38, v114, v122
    v_add_f32 v39, v115, v123
    s_add_u32 s21, s20, 12288
    buffer_store_dwordx4 v[36:39], v1, s[12:15], s21 offen sc0 sc1
    s_waitcnt lgkmcnt(15)
    v_add_f32 v128, v128, v132
    v_add_f32 v136, v136, v140
    v_add_f32 v129, v129, v133
    v_add_f32 v137, v137, v141
    v_add_f32 v130, v130, v134
    v_add_f32 v138, v138, v142
    v_add_f32 v131, v131, v135
    v_add_f32 v139, v139, v143
    v_add_f32 v40, v128, v136
    v_add_f32 v41, v129, v137
    v_add_f32 v42, v130, v138
    v_add_f32 v43, v131, v139
    s_add_u32 s21, s20, 16384
    buffer_store_dwordx4 v[40:43], v1, s[12:15], s21 offen sc0 sc1
    s_waitcnt lgkmcnt(12)
    v_add_f32 v144, v144, v148
    v_add_f32 v152, v152, v156
    v_add_f32 v145, v145, v149
    v_add_f32 v153, v153, v157
    v_add_f32 v146, v146, v150
    v_add_f32 v154, v154, v158
    v_add_f32 v147, v147, v151
    v_add_f32 v155, v155, v159
    v_add_f32 v44, v144, v152
    v_add_f32 v45, v145, v153
    v_add_f32 v46, v146, v154
    v_add_f32 v47, v147, v155
    s_add_u32 s21, s20, 20480
    buffer_store_dwordx4 v[44:47], v1, s[12:15], s21 offen sc0 sc1
    s_waitcnt lgkmcnt(8)
    v_add_f32 v160, v160, v164
    v_add_f32 v168, v168, v172
    v_add_f32 v161, v161, v165
    v_add_f32 v169, v169, v173
    v_add_f32 v162, v162, v166
    v_add_f32 v170, v170, v174
    v_add_f32 v163, v163, v167
    v_add_f32 v171, v171, v175
    v_add_f32 v48, v160, v168
    v_add_f32 v49, v161, v169
    v_add_f32 v50, v162, v170
    v_add_f32 v51, v163, v171
    s_add_u32 s21, s20, 24576
    buffer_store_dwordx4 v[48:51], v1, s[12:15], s21 offen sc0 sc1
    s_waitcnt lgkmcnt(4)
    v_add_f32 v176, v176, v180
    v_add_f32 v184, v184, v188
    v_add_f32 v177, v177, v181
    v_add_f32 v185, v185, v189
    v_add_f32 v178, v178, v182
    v_add_f32 v186, v186, v190
    v_add_f32 v179, v179, v183
    v_add_f32 v187, v187, v191
    v_add_f32 v52, v176, v184
    v_add_f32 v53, v177, v185
    v_add_f32 v54, v178, v186
    v_add_f32 v55, v179, v187
    s_add_u32 s21, s20, 28672
    buffer_store_dwordx4 v[52:55], v1, s[12:15], s21 offen sc0 sc1
    s_waitcnt lgkmcnt(0)
    v_add_f32 v192, v192, v196
    v_add_f32 v200, v200, v204
    v_add_f32 v193, v193, v197
    v_add_f32 v201, v201, v205
    v_add_f32 v194, v194, v198
    v_add_f32 v202, v202, v206
    v_add_f32 v195, v195, v199
    v_add_f32 v203, v203, v207
    v_add_f32 v56, v192, v200
    v_add_f32 v57, v193, v201
    v_add_f32 v58, v194, v202
    v_add_f32 v59, v195, v203
    s_cmp_ge_u32 s19, 3
    s_cbranch_scc1 k2_st_done
    s_add_u32 s21, s20, 32768
    buffer_store_dwordx4 v[56:59], v1, s[12:15], s21 offen sc0 sc1
k2_st_done:
    s_waitcnt vmcnt(0)
    s_barrier
    s_cmp_lg_u32 s19, 0
    s_cbranch_scc1 k2_wait
    s_lshl_b32 s21, s56, 2
    v_mov_b32 v4, 1
    v_mov_b32 v5, s21
    s_mov_b64 s[58:59], exec
    s_mov_b64 exec, 1
    buffer_atomic_add v4, v5, s[52:55], 0 offen sc0 sc1
    s_waitcnt vmcnt(0)
    v_mov_b32 v5, 0
    ds_write_b32 v5, v4
    s_waitcnt lgkmcnt(0)
    s_mov_b64 exec, s[58:59]
k2_wait:
    s_barrier
    v_mov_b32 v5, 0
    ds_read_b32 v4, v5
    s_waitcnt lgkmcnt(0)
    s_nop 0
    v_readfirstlane_b32 s21, v4
    s_nop 3
    s_cmp_lg_u32 s21, 3
    s_cbranch_scc1 k2_done
    v_and_b32 v4, 15, v3
    s_mul_i32 s21, s16, 112
    v_add_u32 v4, s21, v4
    s_movk_i32 s21, 1280
    v_mul_lo_u32 v4, v4, s21
    v_lshrrev_b32 v5, 4, v3
    v_lshl_add_u32 v4, v5, 3, v4
    s_mul_i32 s21, s17, 160
    v_add_u32 v4, s21, v4
    s_add_u32 s21, s57, 0
    buffer_load_dwordx4 v[64:67], v1, s[12:15], s21 offen sc0 sc1
    s_add_u32 s21, s57, 2293760
    buffer_load_dwordx4 v[68:71], v1, s[12:15], s21 offen sc0 sc1
    s_add_u32 s21, s57, 4587520
    buffer_load_dwordx4 v[72:75], v1, s[12:15], s21 offen sc0 sc1
    s_add_u32 s21, s57, 6881280
    buffer_load_dwordx4 v[76:79], v1, s[12:15], s21 offen sc0 sc1
    s_add_u32 s21, s57, 4096
    buffer_load_dwordx4 v[80:83], v1, s[12:15], s21 offen sc0 sc1
    s_add_u32 s21, s57, 2297856
    buffer_load_dwordx4 v[84:87], v1, s[12:15], s21 offen sc0 sc1
    s_add_u32 s21, s57, 4591616
    buffer_load_dwordx4 v[88:91], v1, s[12:15], s21 offen sc0 sc1
    s_add_u32 s21, s57, 6885376
    buffer_load_dwordx4 v[92:95], v1, s[12:15], s21 offen sc0 sc1
    s_add_u32 s21, s57, 8192
    buffer_load_dwordx4 v[96:99], v1, s[12:15], s21 offen sc0 sc1
    s_add_u32 s21, s57, 2301952
    buffer_load_dwordx4 v[100:103], v1, s[12:15], s21 offen sc0 sc1
    s_add_u32 s21, s57, 4595712
    buffer_load_dwordx4 v[104:107], v1, s[12:15], s21 offen sc0 sc1
    s_add_u32 s21, s57, 6889472
    buffer_load_dwordx4 v[108:111], v1, s[12:15], s21 offen sc0 sc1
    s_add_u32 s21, s57, 12288
    buffer_load_dwordx4 v[112:115], v1, s[12:15], s21 offen sc0 sc1
    s_add_u32 s21, s57, 2306048
    buffer_load_dwordx4 v[116:119], v1, s[12:15], s21 offen sc0 sc1
    s_add_u32 s21, s57, 4599808
    buffer_load_dwordx4 v[120:123], v1, s[12:15], s21 offen sc0 sc1
    s_add_u32 s21, s57, 6893568
    buffer_load_dwordx4 v[124:127], v1, s[12:15], s21 offen sc0 sc1
    s_add_u32 s21, s57, 16384
    buffer_load_dwordx4 v[128:131], v1, s[12:15], s21 offen sc0 sc1
    s_add_u32 s21, s57, 2310144
    buffer_load_dwordx4 v[132:135], v1, s[12:15], s21 offen sc0 sc1
    s_add_u32 s21, s57, 4603904
    buffer_load_dwordx4 v[136:139], v1, s[12:15], s21 offen sc0 sc1
    s_add_u32 s21, s57, 6897664
    buffer_load_dwordx4 v[140:143], v1, s[12:15], s21 offen sc0 sc1
    s_add_u32 s21, s57, 20480
    buffer_load_dwordx4 v[144:147], v1, s[12:15], s21 offen sc0 sc1
    s_add_u32 s21, s57, 2314240
    buffer_load_dwordx4 v[148:151], v1, s[12:15], s21 offen sc0 sc1
    s_add_u32 s21, s57, 4608000
    buffer_load_dwordx4 v[152:155], v1, s[12:15], s21 offen sc0 sc1
    s_add_u32 s21, s57, 6901760
    buffer_load_dwordx4 v[156:159], v1, s[12:15], s21 offen sc0 sc1
    s_add_u32 s21, s57, 24576
    buffer_load_dwordx4 v[160:163], v1, s[12:15], s21 offen sc0 sc1
    s_add_u32 s21, s57, 2318336
    buffer_load_dwordx4 v[164:167], v1, s[12:15], s21 offen sc0 sc1
    s_add_u32 s21, s57, 4612096
    buffer_load_dwordx4 v[168:171], v1, s[12:15], s21 offen sc0 sc1
    s_add_u32 s21, s57, 6905856
    buffer_load_dwordx4 v[172:175], v1, s[12:15], s21 offen sc0 sc1
    s_add_u32 s21, s57, 28672
    buffer_load_dwordx4 v[176:179], v1, s[12:15], s21 offen sc0 sc1
    s_add_u32 s21, s57, 2322432
    buffer_load_dwordx4 v[180:183], v1, s[12:15], s21 offen sc0 sc1
    s_add_u32 s21, s57, 4616192
    buffer_load_dwordx4 v[184:187], v1, s[12:15], s21 offen sc0 sc1
    s_add_u32 s21, s57, 6909952
    buffer_load_dwordx4 v[188:191], v1, s[12:15], s21 offen sc0 sc1
    s_add_u32 s21, s57, 32768
    buffer_load_dwordx4 v[192:195], v1, s[12:15], s21 offen sc0 sc1
    s_add_u32 s21, s57, 2326528
    buffer_load_dwordx4 v[196:199], v1, s[12:15], s21 offen sc0 sc1
    s_add_u32 s21, s57, 4620288
    buffer_load_dwordx4 v[200:203], v1, s[12:15], s21 offen sc0 sc1
    s_add_u32 s21, s57, 6914048
    buffer_load_dwordx4 v[204:207], v1, s[12:15], s21 offen sc0 sc1
    s_waitcnt vmcnt(32)
    s_add_u32 s20, s19, 0
    s_mul_i32 s21, s20, 37
    s_lshr_b32 s21, s21, 8
    s_mul_i32 s22, s21, 7
    s_sub_u32 s22, s20, s22
    s_mul_i32 s22, s22, 20480
    s_lshl_b32 s21, s21, 5
    s_add_u32 s21, s21, s22
    v_add_f32 v64, v64, v68
    v_add_f32 v72, v72, v76
    v_add_f32 v65, v65, v69
    v_add_f32 v73, v73, v77
    v_add_f32 v66, v66, v70
    v_add_f32 v74, v74, v78
    v_add_f32 v67, v67, v71
    v_add_f32 v75, v75, v79
    v_add_f32 v64, v64, v72
    v_add_f32 v65, v65, v73
    v_add_f32 v66, v66, v74
    v_add_f32 v67, v67, v75
    v_cvt_pk_bf16_f32 v68, v64, v65
    v_cvt_pk_bf16_f32 v69, v66, v67
    buffer_store_dwordx2 v[68:69], v4, s[40:43], s21 offen
    s_waitcnt vmcnt(29)
    s_add_u32 s20, s19, 4
    s_mul_i32 s21, s20, 37
    s_lshr_b32 s21, s21, 8
    s_mul_i32 s22, s21, 7
    s_sub_u32 s22, s20, s22
    s_mul_i32 s22, s22, 20480
    s_lshl_b32 s21, s21, 5
    s_add_u32 s21, s21, s22
    v_add_f32 v80, v80, v84
    v_add_f32 v88, v88, v92
    v_add_f32 v81, v81, v85
    v_add_f32 v89, v89, v93
    v_add_f32 v82, v82, v86
    v_add_f32 v90, v90, v94
    v_add_f32 v83, v83, v87
    v_add_f32 v91, v91, v95
    v_add_f32 v80, v80, v88
    v_add_f32 v81, v81, v89
    v_add_f32 v82, v82, v90
    v_add_f32 v83, v83, v91
    v_cvt_pk_bf16_f32 v84, v80, v81
    v_cvt_pk_bf16_f32 v85, v82, v83
    buffer_store_dwordx2 v[84:85], v4, s[40:43], s21 offen
    s_waitcnt vmcnt(26)
    s_add_u32 s20, s19, 8
    s_mul_i32 s21, s20, 37
    s_lshr_b32 s21, s21, 8
    s_mul_i32 s22, s21, 7
    s_sub_u32 s22, s20, s22
    s_mul_i32 s22, s22, 20480
    s_lshl_b32 s21, s21, 5
    s_add_u32 s21, s21, s22
    v_add_f32 v96, v96, v100
    v_add_f32 v104, v104, v108
    v_add_f32 v97, v97, v101
    v_add_f32 v105, v105, v109
    v_add_f32 v98, v98, v102
    v_add_f32 v106, v106, v110
    v_add_f32 v99, v99, v103
    v_add_f32 v107, v107, v111
    v_add_f32 v96, v96, v104
    v_add_f32 v97, v97, v105
    v_add_f32 v98, v98, v106
    v_add_f32 v99, v99, v107
    v_cvt_pk_bf16_f32 v100, v96, v97
    v_cvt_pk_bf16_f32 v101, v98, v99
    buffer_store_dwordx2 v[100:101], v4, s[40:43], s21 offen
    s_waitcnt vmcnt(23)
    s_add_u32 s20, s19, 12
    s_mul_i32 s21, s20, 37
    s_lshr_b32 s21, s21, 8
    s_mul_i32 s22, s21, 7
    s_sub_u32 s22, s20, s22
    s_mul_i32 s22, s22, 20480
    s_lshl_b32 s21, s21, 5
    s_add_u32 s21, s21, s22
    v_add_f32 v112, v112, v116
    v_add_f32 v120, v120, v124
    v_add_f32 v113, v113, v117
    v_add_f32 v121, v121, v125
    v_add_f32 v114, v114, v118
    v_add_f32 v122, v122, v126
    v_add_f32 v115, v115, v119
    v_add_f32 v123, v123, v127
    v_add_f32 v112, v112, v120
    v_add_f32 v113, v113, v121
    v_add_f32 v114, v114, v122
    v_add_f32 v115, v115, v123
    v_cvt_pk_bf16_f32 v116, v112, v113
    v_cvt_pk_bf16_f32 v117, v114, v115
    buffer_store_dwordx2 v[116:117], v4, s[40:43], s21 offen
    s_waitcnt vmcnt(20)
    s_add_u32 s20, s19, 16
    s_mul_i32 s21, s20, 37
    s_lshr_b32 s21, s21, 8
    s_mul_i32 s22, s21, 7
    s_sub_u32 s22, s20, s22
    s_mul_i32 s22, s22, 20480
    s_lshl_b32 s21, s21, 5
    s_add_u32 s21, s21, s22
    v_add_f32 v128, v128, v132
    v_add_f32 v136, v136, v140
    v_add_f32 v129, v129, v133
    v_add_f32 v137, v137, v141
    v_add_f32 v130, v130, v134
    v_add_f32 v138, v138, v142
    v_add_f32 v131, v131, v135
    v_add_f32 v139, v139, v143
    v_add_f32 v128, v128, v136
    v_add_f32 v129, v129, v137
    v_add_f32 v130, v130, v138
    v_add_f32 v131, v131, v139
    v_cvt_pk_bf16_f32 v132, v128, v129
    v_cvt_pk_bf16_f32 v133, v130, v131
    buffer_store_dwordx2 v[132:133], v4, s[40:43], s21 offen
    s_waitcnt vmcnt(17)
    s_add_u32 s20, s19, 20
    s_mul_i32 s21, s20, 37
    s_lshr_b32 s21, s21, 8
    s_mul_i32 s22, s21, 7
    s_sub_u32 s22, s20, s22
    s_mul_i32 s22, s22, 20480
    s_lshl_b32 s21, s21, 5
    s_add_u32 s21, s21, s22
    v_add_f32 v144, v144, v148
    v_add_f32 v152, v152, v156
    v_add_f32 v145, v145, v149
    v_add_f32 v153, v153, v157
    v_add_f32 v146, v146, v150
    v_add_f32 v154, v154, v158
    v_add_f32 v147, v147, v151
    v_add_f32 v155, v155, v159
    v_add_f32 v144, v144, v152
    v_add_f32 v145, v145, v153
    v_add_f32 v146, v146, v154
    v_add_f32 v147, v147, v155
    v_cvt_pk_bf16_f32 v148, v144, v145
    v_cvt_pk_bf16_f32 v149, v146, v147
    buffer_store_dwordx2 v[148:149], v4, s[40:43], s21 offen
    s_waitcnt vmcnt(14)
    s_add_u32 s20, s19, 24
    s_mul_i32 s21, s20, 37
    s_lshr_b32 s21, s21, 8
    s_mul_i32 s22, s21, 7
    s_sub_u32 s22, s20, s22
    s_mul_i32 s22, s22, 20480
    s_lshl_b32 s21, s21, 5
    s_add_u32 s21, s21, s22
    v_add_f32 v160, v160, v164
    v_add_f32 v168, v168, v172
    v_add_f32 v161, v161, v165
    v_add_f32 v169, v169, v173
    v_add_f32 v162, v162, v166
    v_add_f32 v170, v170, v174
    v_add_f32 v163, v163, v167
    v_add_f32 v171, v171, v175
    v_add_f32 v160, v160, v168
    v_add_f32 v161, v161, v169
    v_add_f32 v162, v162, v170
    v_add_f32 v163, v163, v171
    v_cvt_pk_bf16_f32 v164, v160, v161
    v_cvt_pk_bf16_f32 v165, v162, v163
    buffer_store_dwordx2 v[164:165], v4, s[40:43], s21 offen
    s_waitcnt vmcnt(11)
    s_add_u32 s20, s19, 28
    s_mul_i32 s21, s20, 37
    s_lshr_b32 s21, s21, 8
    s_mul_i32 s22, s21, 7
    s_sub_u32 s22, s20, s22
    s_mul_i32 s22, s22, 20480
    s_lshl_b32 s21, s21, 5
    s_add_u32 s21, s21, s22
    v_add_f32 v176, v176, v180
    v_add_f32 v184, v184, v188
    v_add_f32 v177, v177, v181
    v_add_f32 v185, v185, v189
    v_add_f32 v178, v178, v182
    v_add_f32 v186, v186, v190
    v_add_f32 v179, v179, v183
    v_add_f32 v187, v187, v191
    v_add_f32 v176, v176, v184
    v_add_f32 v177, v177, v185
    v_add_f32 v178, v178, v186
    v_add_f32 v179, v179, v187
    v_cvt_pk_bf16_f32 v180, v176, v177
    v_cvt_pk_bf16_f32 v181, v178, v179
    buffer_store_dwordx2 v[180:181], v4, s[40:43], s21 offen
    s_cmp_ge_u32 s19, 3
    s_cbranch_scc1 k2_done
    s_waitcnt vmcnt(8)
    s_add_u32 s20, s19, 32
    s_mul_i32 s21, s20, 37
    s_lshr_b32 s21, s21, 8
    s_mul_i32 s22, s21, 7
    s_sub_u32 s22, s20, s22
    s_mul_i32 s22, s22, 20480
    s_lshl_b32 s21, s21, 5
    s_add_u32 s21, s21, s22
    v_add_f32 v192, v192, v196
    v_add_f32 v200, v200, v204
    v_add_f32 v193, v193, v197
    v_add_f32 v201, v201, v205
    v_add_f32 v194, v194, v198
    v_add_f32 v202, v202, v206
    v_add_f32 v195, v195, v199
    v_add_f32 v203, v203, v207
    v_add_f32 v192, v192, v200
    v_add_f32 v193, v193, v201
    v_add_f32 v194, v194, v202
    v_add_f32 v195, v195, v203
    v_cvt_pk_bf16_f32 v196, v192, v193
    v_cvt_pk_bf16_f32 v197, v194, v195
    buffer_store_dwordx2 v[196:197], v4, s[40:43], s21 offen
k2_done:
    s_endpgm
.section .rodata,"a"
.p2align 6
.amdhsa_kernel k1_kernel
  .amdhsa_next_free_vgpr 512
  .amdhsa_next_free_sgpr 102
  .amdhsa_accum_offset 256
  .amdhsa_group_segment_fixed_size 0
  .amdhsa_kernarg_size 64
  .amdhsa_user_sgpr_count 2
  .amdhsa_user_sgpr_kernarg_segment_ptr 1
  .amdhsa_system_sgpr_workgroup_id_x 1
.end_amdhsa_kernel
.p2align 6
.amdhsa_kernel k2_kernel
  .amdhsa_next_free_vgpr 348
  .amdhsa_next_free_sgpr 102
  .amdhsa_accum_offset 208
  .amdhsa_group_segment_fixed_size 0
  .amdhsa_kernarg_size 64
  .amdhsa_user_sgpr_count 2
  .amdhsa_user_sgpr_kernarg_segment_ptr 1
  .amdhsa_system_sgpr_workgroup_id_x 1
.end_amdhsa_kernel
```
